```python
import torch

def _softmax(x, axis=-1):
    return torch.softmax(x, dim=axis)
def _gelu(x):
    return torch.nn.functional.gelu(x, approximate="tanh")
def _silu(x):
    return torch.nn.functional.silu(x)
def _sigmoid(x):
    return torch.sigmoid(x)
def _layernorm(x, axis=-1, eps=1e-5):
    m = x.mean(dim=axis, keepdim=True)
    v = x.var(dim=axis, keepdim=True, unbiased=False)
    return (x - m) / torch.sqrt(v + eps)
def _scatter_add(tgt, idx, src, axis=0):
    return tgt.clone().index_add_(axis, idx, src)
def _segment_sum(src, seg, n):
    out = torch.zeros((n,) + src.shape[1:], dtype=src.dtype)
    return out.index_add_(0, seg, src)
def _pad(x, pw):
    flat = tuple(v for pair in reversed(pw) for v in pair)
    return torch.nn.functional.pad(x, flat)

kernel_name = 'sequential_preLN__mha_block__moe_arch_mod__prompt'

def setup_inputs():

    _w = (lambda a: (lambda t: t.to(torch.bfloat16) if t.is_floating_point() else t)(torch.as_tensor(a)))
    def _A_setup():
        B, S, D, H = 1, 2048, 640, 32
        return {
            "x": _w((lambda *s: torch.randn(*s, dtype=torch.bfloat16) * 0.05)(B, S, D)),
            "wqkv": _w((lambda *s: torch.randn(*s, dtype=torch.bfloat16) * 0.05)(D, 3 * D)),
            "wo": _w((lambda *s: torch.randn(*s, dtype=torch.bfloat16) * 0.05)(D, D)),
        }
    _A_in = _A_setup()

    def _B_setup():
        B, S, D, F, C = 1, 2048, 640, 1728, 1
        return {
            "x": _w((lambda *s: torch.randn(*s, dtype=torch.bfloat16) * 0.05)(B, S, D)),
            "w_r": _w((lambda *s: torch.randn(*s, dtype=torch.bfloat16) * 0.05)(D)),
            "w_gate": _w((lambda *s: torch.randn(*s, dtype=torch.bfloat16) * 0.05)(D, F)),
            "w_up": _w((lambda *s: torch.randn(*s, dtype=torch.bfloat16) * 0.05)(D, F)),
            "w_down": _w((lambda *s: torch.randn(*s, dtype=torch.bfloat16) * 0.05)(F, D)),
        }
    _B_in = _B_setup()

    return {
        "A_x": _A_in["x"],
        "A_wqkv": _A_in["wqkv"],
        "A_wo": _A_in["wo"],
        "B_x": _B_in["x"],
        "B_w_r": _B_in["w_r"],
        "B_w_gate": _B_in["w_gate"],
        "B_w_up": _B_in["w_up"],
        "B_w_down": _B_in["w_down"],
    }

def reference(A_x, A_wqkv, A_wo, B_x, B_w_r, B_w_gate, B_w_up, B_w_down):
    def _A_ref(x, wqkv, wo):
        B, S, D = x.shape
        H = 32
        Dh = D // H
        qkv = (lambda x, *d: x.permute(*d))((x @ wqkv).reshape(B, S, 3, H, Dh), 2, 0, 3, 1, 4)
        q, k, v = qkv[0], qkv[1], qkv[2]
        scores = torch.einsum("bhqd,bhkd->bhqk", q, k) * (Dh ** -0.5)
        p = _softmax(scores, axis=-1)
        o = torch.einsum("bhqk,bhkd->bhqd", p, v)
        return (lambda x, *d: x.permute(*d))(o, 0, 2, 1, 3).reshape(B, S, D) @ wo

    def _B_ref(x, w_r, w_gate, w_up, w_down):
        B, S, D = x.shape
        C = 1
        r = x @ w_r
        idx = torch.argsort(-r, axis=-1)[:, :C]
        idx_e = (lambda x, n, axis: torch.repeat_interleave(x, n, dim=axis))(idx.reshape(B, C, 1), D, axis=2)
        x_sel = (lambda x, i, axis: torch.take_along_dim(x, i, dim=axis))(x, idx_e, axis=1)
        g = _silu(x_sel @ w_gate)
        u = x_sel @ w_up
        y = (g * u) @ w_down
        r_sel = _sigmoid((lambda x, i, axis: torch.take_along_dim(x, i, dim=axis))(r, idx, axis=1))
        y = y * r_sel.reshape(B, C, 1)
        b_off = (torch.arange(B) * S).reshape(B, 1)
        flat_idx = (idx + b_off).reshape(B * C)
        zero = (x * 0.0).reshape(B * S, D)
        upd = _scatter_add(zero, flat_idx, y.reshape(B * C, D), axis=0)
        return x + upd.reshape(B, S, D)

    x = A_x
    h = x + _A_ref(_layernorm(x, axis=-1), A_wqkv, A_wo)
    h2 = h + _B_ref(_layernorm(h, axis=-1), B_w_r, B_w_gate, B_w_up, B_w_down)
    return h2
```

```asm
; @launch kernel=sequential_preLN__mha_block__moe_arch_mod__prompt_kernel grid=(256,1,1) block=(512,1,1) lds=163840
.amdgcn_target "amdgcn-amd-amdhsa--gfx950"
.text
.globl sequential_preLN__mha_block__moe_arch_mod__prompt_kernel
.p2align 8
.type sequential_preLN__mha_block__moe_arch_mod__prompt_kernel,@function
sequential_preLN__mha_block__moe_arch_mod__prompt_kernel:
    s_load_dwordx4 s[4:7], s[0:1], 0
    s_load_dwordx2 s[8:9], s[0:1], 80
    s_load_dwordx2 s[44:45], s[0:1], 72
    s_cmp_ge_u32 s2, 256
    s_cbranch_scc1 K1_END
    v_lshrrev_b32 v1, 6, v0
    s_and_b32 s3, s2, 7
    s_lshr_b32 s10, s2, 3
    v_readfirstlane_b32 s26, v1
    s_lshl_b32 s24, s3, 2
    s_and_b32 s11, s10, 3
    s_add_u32 s24, s24, s11
    s_lshr_b32 s25, s10, 2
    s_mul_i32 s27, s3, 10
    s_add_u32 s27, s27, s10
    s_sub_u32 s27, s27, 20
    s_and_b32 s28, s27, 3
    s_lshr_b32 s27, s27, 2
    s_add_u32 s27, s27, 5
    s_cmp_ge_u32 s10, 20
    s_cselect_b32 s24, s28, s24
    s_cselect_b32 s25, s27, s25
    s_mul_i32 s27, s10, 43
    s_lshr_b32 s27, s27, 8
    s_mul_i32 s28, s27, 6
    s_sub_u32 s28, s10, s28
    s_bfe_u32 s29, s3, 0x10001
    s_mul_i32 s29, s29, 6
    s_add_u32 s28, s28, s29
    s_add_u32 s28, s28, 4
    s_and_b32 s29, s3, 1
    s_mul_i32 s29, s29, 5
    s_add_u32 s27, s27, s29
    s_add_u32 s27, s27, 5
    s_cmp_ge_u32 s3, 4
    s_cselect_b32 s24, s28, s24
    s_cselect_b32 s25, s27, s25
    s_lshl_b32 s27, s3, 1
    s_add_u32 s27, s27, s10
    s_sub_u32 s27, s27, 30
    s_cmp_ge_u32 s10, 30
    s_cselect_b32 s24, s27, s24
    s_cselect_b32 s25, 15, s25
    s_mov_b32 s11, s25
    v_and_b32 v1, 63, v0
    s_cmp_eq_u32 s25, 15
    s_cbranch_scc1 K1_SPARE
    s_cmp_lt_u32 s26, 4
    s_cbranch_scc1 K1_COMP
    s_cmp_eq_u32 s26, 5
    s_cbranch_scc1 K1_L1
    s_cmp_gt_u32 s26, 5
    s_cbranch_scc1 K1_L2
    s_setprio 3
    v_lshrrev_b32 v3, 4, v1
    v_and_b32 v7, 15, v1
    v_lshrrev_b32 v2, 3, v1
    s_lshl_b32 s27, s24, 7
    v_add_u32 v2, s27, v2
    v_mul_u32_u24 v2, 1280, v2
    v_and_b32 v4, 7, v1
    v_xor_b32 v4, v4, v3
    v_lshl_add_u32 v8, v4, 4, v2
    v_xor_b32 v4, 4, v4
    v_lshl_add_u32 v9, v4, 4, v2
    v_add_u32 v9, 9216, v9
    v_add_u32 v10, 18432, v8
    v_add_u32 v11, 18432, v9
    s_mul_i32 s30, s11, 3
    s_mov_b32 s31, s24
    s_mul_i32 s31, s31, 1
    s_add_u32 s30, s30, s31
    s_mul_i32 s31, s3, 0
    s_add_u32 s30, s30, s31
    s_mul_i32 s31, s30, 205
    s_lshr_b32 s31, s31, 11
    s_mul_i32 s31, s31, 10
    s_sub_u32 s30, s30, s31
    s_lshl_b32 s30, s30, 7
    s_waitcnt lgkmcnt(0)
    s_mov_b32 s12, s4
    s_mov_b32 s13, s5
    s_mov_b32 s14, 0x280000
    s_mov_b32 s15, 0x00020000
    s_mov_b32 m0, 0
    s_add_u32 s31, s30, 0
    buffer_load_dwordx4 v8, s[12:15], s31 offen offset:0 lds
    buffer_load_dwordx4 v9, s[12:15], s31 offen offset:1024 lds
    buffer_load_dwordx4 v10, s[12:15], s31 offen offset:2048 lds
    buffer_load_dwordx4 v11, s[12:15], s31 offen offset:3072 lds
    s_mov_b32 m0, 4096
    s_add_u32 s31, s30, 40960
    buffer_load_dwordx4 v8, s[12:15], s31 offen offset:0 lds
    buffer_load_dwordx4 v9, s[12:15], s31 offen offset:1024 lds
    buffer_load_dwordx4 v10, s[12:15], s31 offen offset:2048 lds
    buffer_load_dwordx4 v11, s[12:15], s31 offen offset:3072 lds
    s_mov_b32 m0, 8192
    s_add_u32 s31, s30, 81920
    buffer_load_dwordx4 v8, s[12:15], s31 offen offset:0 lds
    buffer_load_dwordx4 v9, s[12:15], s31 offen offset:1024 lds
    buffer_load_dwordx4 v10, s[12:15], s31 offen offset:2048 lds
    buffer_load_dwordx4 v11, s[12:15], s31 offen offset:3072 lds
    s_mov_b32 m0, 12288
    s_add_u32 s31, s30, 122880
    buffer_load_dwordx4 v8, s[12:15], s31 offen offset:0 lds
    buffer_load_dwordx4 v9, s[12:15], s31 offen offset:1024 lds
    buffer_load_dwordx4 v10, s[12:15], s31 offen offset:2048 lds
    buffer_load_dwordx4 v11, s[12:15], s31 offen offset:3072 lds
    s_add_u32 s30, s30, 128
    s_cmp_eq_u32 s30, 1280
    s_cselect_b32 s30, 0, s30
    s_mov_b32 m0, 32768
    s_add_u32 s31, s30, 0
    buffer_load_dwordx4 v8, s[12:15], s31 offen offset:0 lds
    buffer_load_dwordx4 v9, s[12:15], s31 offen offset:1024 lds
    buffer_load_dwordx4 v10, s[12:15], s31 offen offset:2048 lds
    buffer_load_dwordx4 v11, s[12:15], s31 offen offset:3072 lds
    s_mov_b32 m0, 36864
    s_add_u32 s31, s30, 40960
    buffer_load_dwordx4 v8, s[12:15], s31 offen offset:0 lds
    buffer_load_dwordx4 v9, s[12:15], s31 offen offset:1024 lds
    buffer_load_dwordx4 v10, s[12:15], s31 offen offset:2048 lds
    buffer_load_dwordx4 v11, s[12:15], s31 offen offset:3072 lds
    s_mov_b32 m0, 40960
    s_add_u32 s31, s30, 81920
    buffer_load_dwordx4 v8, s[12:15], s31 offen offset:0 lds
    buffer_load_dwordx4 v9, s[12:15], s31 offen offset:1024 lds
    buffer_load_dwordx4 v10, s[12:15], s31 offen offset:2048 lds
    buffer_load_dwordx4 v11, s[12:15], s31 offen offset:3072 lds
    s_mov_b32 m0, 45056
    s_add_u32 s31, s30, 122880
    buffer_load_dwordx4 v8, s[12:15], s31 offen offset:0 lds
    buffer_load_dwordx4 v9, s[12:15], s31 offen offset:1024 lds
    buffer_load_dwordx4 v10, s[12:15], s31 offen offset:2048 lds
    buffer_load_dwordx4 v11, s[12:15], s31 offen offset:3072 lds
    s_mov_b32 s20, s8
    s_mov_b32 s21, s9
    s_mov_b32 s22, 0xe4c400
    s_mov_b32 s23, 0x00020000
    s_mov_b32 s40, s44
    s_mov_b32 s41, s45
    s_mov_b32 s42, 0x100
    s_mov_b32 s43, 0x00020000
    s_waitcnt vmcnt(16)
    s_barrier
    s_add_u32 s30, s30, 128
    s_cmp_eq_u32 s30, 1280
    s_cselect_b32 s30, 0, s30
    s_mov_b32 m0, 65536
    s_add_u32 s31, s30, 0
    buffer_load_dwordx4 v8, s[12:15], s31 offen offset:0 lds
    buffer_load_dwordx4 v9, s[12:15], s31 offen offset:1024 lds
    buffer_load_dwordx4 v10, s[12:15], s31 offen offset:2048 lds
    buffer_load_dwordx4 v11, s[12:15], s31 offen offset:3072 lds
    s_mov_b32 m0, 69632
    s_add_u32 s31, s30, 40960
    buffer_load_dwordx4 v8, s[12:15], s31 offen offset:0 lds
    buffer_load_dwordx4 v9, s[12:15], s31 offen offset:1024 lds
    buffer_load_dwordx4 v10, s[12:15], s31 offen offset:2048 lds
    buffer_load_dwordx4 v11, s[12:15], s31 offen offset:3072 lds
    s_mov_b32 m0, 73728
    s_add_u32 s31, s30, 81920
    buffer_load_dwordx4 v8, s[12:15], s31 offen offset:0 lds
    buffer_load_dwordx4 v9, s[12:15], s31 offen offset:1024 lds
    buffer_load_dwordx4 v10, s[12:15], s31 offen offset:2048 lds
    buffer_load_dwordx4 v11, s[12:15], s31 offen offset:3072 lds
    s_mov_b32 m0, 77824
    s_add_u32 s31, s30, 122880
    buffer_load_dwordx4 v8, s[12:15], s31 offen offset:0 lds
    buffer_load_dwordx4 v9, s[12:15], s31 offen offset:1024 lds
    buffer_load_dwordx4 v10, s[12:15], s31 offen offset:2048 lds
    buffer_load_dwordx4 v11, s[12:15], s31 offen offset:3072 lds
    s_waitcnt vmcnt(16)
    s_barrier
    s_add_u32 s30, s30, 128
    s_cmp_eq_u32 s30, 1280
    s_cselect_b32 s30, 0, s30
    s_mov_b32 m0, 98304
    s_add_u32 s31, s30, 0
    buffer_load_dwordx4 v8, s[12:15], s31 offen offset:0 lds
    buffer_load_dwordx4 v9, s[12:15], s31 offen offset:1024 lds
    buffer_load_dwordx4 v10, s[12:15], s31 offen offset:2048 lds
    buffer_load_dwordx4 v11, s[12:15], s31 offen offset:3072 lds
    s_mov_b32 m0, 102400
    s_add_u32 s31, s30, 40960
    buffer_load_dwordx4 v8, s[12:15], s31 offen offset:0 lds
    buffer_load_dwordx4 v9, s[12:15], s31 offen offset:1024 lds
    buffer_load_dwordx4 v10, s[12:15], s31 offen offset:2048 lds
    buffer_load_dwordx4 v11, s[12:15], s31 offen offset:3072 lds
    s_mov_b32 m0, 106496
    s_add_u32 s31, s30, 81920
    buffer_load_dwordx4 v8, s[12:15], s31 offen offset:0 lds
    buffer_load_dwordx4 v9, s[12:15], s31 offen offset:1024 lds
    buffer_load_dwordx4 v10, s[12:15], s31 offen offset:2048 lds
    buffer_load_dwordx4 v11, s[12:15], s31 offen offset:3072 lds
    s_mov_b32 m0, 110592
    s_add_u32 s31, s30, 122880
    buffer_load_dwordx4 v8, s[12:15], s31 offen offset:0 lds
    buffer_load_dwordx4 v9, s[12:15], s31 offen offset:1024 lds
    buffer_load_dwordx4 v10, s[12:15], s31 offen offset:2048 lds
    buffer_load_dwordx4 v11, s[12:15], s31 offen offset:3072 lds
    s_waitcnt vmcnt(16)
    s_barrier
    s_add_u32 s30, s30, 128
    s_cmp_eq_u32 s30, 1280
    s_cselect_b32 s30, 0, s30
    s_mov_b32 m0, 0
    s_add_u32 s31, s30, 0
    buffer_load_dwordx4 v8, s[12:15], s31 offen offset:0 lds
    buffer_load_dwordx4 v9, s[12:15], s31 offen offset:1024 lds
    buffer_load_dwordx4 v10, s[12:15], s31 offen offset:2048 lds
    buffer_load_dwordx4 v11, s[12:15], s31 offen offset:3072 lds
    s_mov_b32 m0, 4096
    s_add_u32 s31, s30, 40960
    buffer_load_dwordx4 v8, s[12:15], s31 offen offset:0 lds
    buffer_load_dwordx4 v9, s[12:15], s31 offen offset:1024 lds
    buffer_load_dwordx4 v10, s[12:15], s31 offen offset:2048 lds
    buffer_load_dwordx4 v11, s[12:15], s31 offen offset:3072 lds
    s_mov_b32 m0, 8192
    s_add_u32 s31, s30, 81920
    buffer_load_dwordx4 v8, s[12:15], s31 offen offset:0 lds
    buffer_load_dwordx4 v9, s[12:15], s31 offen offset:1024 lds
    buffer_load_dwordx4 v10, s[12:15], s31 offen offset:2048 lds
    buffer_load_dwordx4 v11, s[12:15], s31 offen offset:3072 lds
    s_mov_b32 m0, 12288
    s_add_u32 s31, s30, 122880
    buffer_load_dwordx4 v8, s[12:15], s31 offen offset:0 lds
    buffer_load_dwordx4 v9, s[12:15], s31 offen offset:1024 lds
    buffer_load_dwordx4 v10, s[12:15], s31 offen offset:2048 lds
    buffer_load_dwordx4 v11, s[12:15], s31 offen offset:3072 lds
    s_waitcnt vmcnt(16)
    s_barrier
    s_add_u32 s30, s30, 128
    s_cmp_eq_u32 s30, 1280
    s_cselect_b32 s30, 0, s30
    s_mov_b32 m0, 32768
    s_add_u32 s31, s30, 0
    buffer_load_dwordx4 v8, s[12:15], s31 offen offset:0 lds
    buffer_load_dwordx4 v9, s[12:15], s31 offen offset:1024 lds
    buffer_load_dwordx4 v10, s[12:15], s31 offen offset:2048 lds
    buffer_load_dwordx4 v11, s[12:15], s31 offen offset:3072 lds
    s_mov_b32 m0, 36864
    s_add_u32 s31, s30, 40960
    buffer_load_dwordx4 v8, s[12:15], s31 offen offset:0 lds
    buffer_load_dwordx4 v9, s[12:15], s31 offen offset:1024 lds
    buffer_load_dwordx4 v10, s[12:15], s31 offen offset:2048 lds
    buffer_load_dwordx4 v11, s[12:15], s31 offen offset:3072 lds
    s_mov_b32 m0, 40960
    s_add_u32 s31, s30, 81920
    buffer_load_dwordx4 v8, s[12:15], s31 offen offset:0 lds
    buffer_load_dwordx4 v9, s[12:15], s31 offen offset:1024 lds
    buffer_load_dwordx4 v10, s[12:15], s31 offen offset:2048 lds
    buffer_load_dwordx4 v11, s[12:15], s31 offen offset:3072 lds
    s_mov_b32 m0, 45056
    s_add_u32 s31, s30, 122880
    buffer_load_dwordx4 v8, s[12:15], s31 offen offset:0 lds
    buffer_load_dwordx4 v9, s[12:15], s31 offen offset:1024 lds
    buffer_load_dwordx4 v10, s[12:15], s31 offen offset:2048 lds
    buffer_load_dwordx4 v11, s[12:15], s31 offen offset:3072 lds
    s_waitcnt vmcnt(16)
    s_barrier
    s_add_u32 s30, s30, 128
    s_cmp_eq_u32 s30, 1280
    s_cselect_b32 s30, 0, s30
    s_mov_b32 m0, 65536
    s_add_u32 s31, s30, 0
    buffer_load_dwordx4 v8, s[12:15], s31 offen offset:0 lds
    buffer_load_dwordx4 v9, s[12:15], s31 offen offset:1024 lds
    buffer_load_dwordx4 v10, s[12:15], s31 offen offset:2048 lds
    buffer_load_dwordx4 v11, s[12:15], s31 offen offset:3072 lds
    s_mov_b32 m0, 69632
    s_add_u32 s31, s30, 40960
    buffer_load_dwordx4 v8, s[12:15], s31 offen offset:0 lds
    buffer_load_dwordx4 v9, s[12:15], s31 offen offset:1024 lds
    buffer_load_dwordx4 v10, s[12:15], s31 offen offset:2048 lds
    buffer_load_dwordx4 v11, s[12:15], s31 offen offset:3072 lds
    s_mov_b32 m0, 73728
    s_add_u32 s31, s30, 81920
    buffer_load_dwordx4 v8, s[12:15], s31 offen offset:0 lds
    buffer_load_dwordx4 v9, s[12:15], s31 offen offset:1024 lds
    buffer_load_dwordx4 v10, s[12:15], s31 offen offset:2048 lds
    buffer_load_dwordx4 v11, s[12:15], s31 offen offset:3072 lds
    s_mov_b32 m0, 77824
    s_add_u32 s31, s30, 122880
    buffer_load_dwordx4 v8, s[12:15], s31 offen offset:0 lds
    buffer_load_dwordx4 v9, s[12:15], s31 offen offset:1024 lds
    buffer_load_dwordx4 v10, s[12:15], s31 offen offset:2048 lds
    buffer_load_dwordx4 v11, s[12:15], s31 offen offset:3072 lds
    s_waitcnt vmcnt(16)
    s_barrier
    s_add_u32 s30, s30, 128
    s_cmp_eq_u32 s30, 1280
    s_cselect_b32 s30, 0, s30
    s_mov_b32 m0, 98304
    s_add_u32 s31, s30, 0
    buffer_load_dwordx4 v8, s[12:15], s31 offen offset:0 lds
    buffer_load_dwordx4 v9, s[12:15], s31 offen offset:1024 lds
    buffer_load_dwordx4 v10, s[12:15], s31 offen offset:2048 lds
    buffer_load_dwordx4 v11, s[12:15], s31 offen offset:3072 lds
    s_mov_b32 m0, 102400
    s_add_u32 s31, s30, 40960
    buffer_load_dwordx4 v8, s[12:15], s31 offen offset:0 lds
    buffer_load_dwordx4 v9, s[12:15], s31 offen offset:1024 lds
    buffer_load_dwordx4 v10, s[12:15], s31 offen offset:2048 lds
    buffer_load_dwordx4 v11, s[12:15], s31 offen offset:3072 lds
    s_mov_b32 m0, 106496
    s_add_u32 s31, s30, 81920
    buffer_load_dwordx4 v8, s[12:15], s31 offen offset:0 lds
    buffer_load_dwordx4 v9, s[12:15], s31 offen offset:1024 lds
    buffer_load_dwordx4 v10, s[12:15], s31 offen offset:2048 lds
    buffer_load_dwordx4 v11, s[12:15], s31 offen offset:3072 lds
    s_mov_b32 m0, 110592
    s_add_u32 s31, s30, 122880
    buffer_load_dwordx4 v8, s[12:15], s31 offen offset:0 lds
    buffer_load_dwordx4 v9, s[12:15], s31 offen offset:1024 lds
    buffer_load_dwordx4 v10, s[12:15], s31 offen offset:2048 lds
    buffer_load_dwordx4 v11, s[12:15], s31 offen offset:3072 lds
    s_waitcnt vmcnt(16)
    s_barrier
    s_add_u32 s30, s30, 128
    s_cmp_eq_u32 s30, 1280
    s_cselect_b32 s30, 0, s30
    s_mov_b32 m0, 0
    s_add_u32 s31, s30, 0
    buffer_load_dwordx4 v8, s[12:15], s31 offen offset:0 lds
    buffer_load_dwordx4 v9, s[12:15], s31 offen offset:1024 lds
    buffer_load_dwordx4 v10, s[12:15], s31 offen offset:2048 lds
    buffer_load_dwordx4 v11, s[12:15], s31 offen offset:3072 lds
    s_mov_b32 m0, 4096
    s_add_u32 s31, s30, 40960
    buffer_load_dwordx4 v8, s[12:15], s31 offen offset:0 lds
    buffer_load_dwordx4 v9, s[12:15], s31 offen offset:1024 lds
    buffer_load_dwordx4 v10, s[12:15], s31 offen offset:2048 lds
    buffer_load_dwordx4 v11, s[12:15], s31 offen offset:3072 lds
    s_mov_b32 m0, 8192
    s_add_u32 s31, s30, 81920
    buffer_load_dwordx4 v8, s[12:15], s31 offen offset:0 lds
    buffer_load_dwordx4 v9, s[12:15], s31 offen offset:1024 lds
    buffer_load_dwordx4 v10, s[12:15], s31 offen offset:2048 lds
    buffer_load_dwordx4 v11, s[12:15], s31 offen offset:3072 lds
    s_mov_b32 m0, 12288
    s_add_u32 s31, s30, 122880
    buffer_load_dwordx4 v8, s[12:15], s31 offen offset:0 lds
    buffer_load_dwordx4 v9, s[12:15], s31 offen offset:1024 lds
    buffer_load_dwordx4 v10, s[12:15], s31 offen offset:2048 lds
    buffer_load_dwordx4 v11, s[12:15], s31 offen offset:3072 lds
    buffer_load_dword v36, off, s[40:43], 0 sc1
    s_lshl_b32 s27, s25, 14
    s_add_u32 s37, s27, 14059520
    v_lshlrev_b32 v6, 12, v3
    v_lshl_add_u32 v6, v7, 4, v6
    s_mov_b32 s28, 132096
    v_lshrrev_b32 v37, 5, v1
    v_lshl_add_u32 v37, v7, 1, v37
    v_lshl_add_u32 v37, v37, 2, s28
    s_lshl_b32 s27, s24, 11
    s_add_u32 s35, s27, 14026752
    v_lshlrev_b32 v4, 4, v1
    s_mov_b32 s28, 131072
    v_lshl_add_u32 v5, v1, 2, s28
    s_cmp_ge_u32 s25, 5
    s_cselect_b32 s38, 1.0, 0x3ea52b5c
    s_waitcnt vmcnt(17)
    s_barrier
    s_add_u32 s30, s30, 128
    s_cmp_eq_u32 s30, 1280
    s_cselect_b32 s30, 0, s30
    s_mov_b32 m0, 32768
    s_add_u32 s31, s30, 0
    buffer_load_dwordx4 v8, s[12:15], s31 offen offset:0 lds
    buffer_load_dwordx4 v9, s[12:15], s31 offen offset:1024 lds
    buffer_load_dwordx4 v10, s[12:15], s31 offen offset:2048 lds
    buffer_load_dwordx4 v11, s[12:15], s31 offen offset:3072 lds
    s_mov_b32 m0, 36864
    s_add_u32 s31, s30, 40960
    buffer_load_dwordx4 v8, s[12:15], s31 offen offset:0 lds
    buffer_load_dwordx4 v9, s[12:15], s31 offen offset:1024 lds
    buffer_load_dwordx4 v10, s[12:15], s31 offen offset:2048 lds
    buffer_load_dwordx4 v11, s[12:15], s31 offen offset:3072 lds
    s_mov_b32 m0, 40960
    s_add_u32 s31, s30, 81920
    buffer_load_dwordx4 v8, s[12:15], s31 offen offset:0 lds
    buffer_load_dwordx4 v9, s[12:15], s31 offen offset:1024 lds
    buffer_load_dwordx4 v10, s[12:15], s31 offen offset:2048 lds
    buffer_load_dwordx4 v11, s[12:15], s31 offen offset:3072 lds
    s_mov_b32 m0, 45056
    s_add_u32 s31, s30, 122880
    buffer_load_dwordx4 v8, s[12:15], s31 offen offset:0 lds
    buffer_load_dwordx4 v9, s[12:15], s31 offen offset:1024 lds
    buffer_load_dwordx4 v10, s[12:15], s31 offen offset:2048 lds
    buffer_load_dwordx4 v11, s[12:15], s31 offen offset:3072 lds
    s_waitcnt vmcnt(16)
    v_readfirstlane_b32 s34, v36
    s_mov_b32 s48, 262144
    s_cmp_lg_u32 s34, 0
    s_cbranch_scc1 K1_N01
K1_N00:
    s_sub_u32 s48, s48, 1
    s_cbranch_scc1 K1_N01
    buffer_load_dword v36, off, s[40:43], 0 sc1
    s_waitcnt vmcnt(0)
    v_readfirstlane_b32 s34, v36
    s_cmp_eq_u32 s34, 0
    s_cbranch_scc1 K1_N00
K1_N01:
    buffer_load_dwordx4 v[52:55], v6, s[20:23], s37 offen offset:0 sc1
    buffer_load_dwordx4 v[56:59], v6, s[20:23], s37 offen offset:1024 sc1
    buffer_load_dwordx4 v[60:63], v6, s[20:23], s37 offen offset:2048 sc1
    buffer_load_dwordx4 v[64:67], v6, s[20:23], s37 offen offset:3072 sc1
    buffer_load_dwordx4 v[48:51], v4, s[20:23], s35 offen sc1
    s_barrier
    s_waitcnt vmcnt(5)
    s_barrier
K1_G0:
    s_waitcnt vmcnt(0)
    v_cmp_ne_u32 vcc, s34, v49
    v_cmp_ne_u32 s[46:47], s34, v51
    s_or_b64 vcc, vcc, s[46:47]
    v_cmp_ne_u32 s[46:47], s34, v54
    s_or_b64 vcc, vcc, s[46:47]
    v_cmp_ne_u32 s[46:47], s34, v55
    s_or_b64 vcc, vcc, s[46:47]
    v_cmp_ne_u32 s[46:47], s34, v58
    s_or_b64 vcc, vcc, s[46:47]
    v_cmp_ne_u32 s[46:47], s34, v59
    s_or_b64 vcc, vcc, s[46:47]
    v_cmp_ne_u32 s[46:47], s34, v62
    s_or_b64 vcc, vcc, s[46:47]
    v_cmp_ne_u32 s[46:47], s34, v63
    s_or_b64 vcc, vcc, s[46:47]
    v_cmp_ne_u32 s[46:47], s34, v66
    s_or_b64 vcc, vcc, s[46:47]
    v_cmp_ne_u32 s[46:47], s34, v67
    s_or_b64 vcc, vcc, s[46:47]
    s_cbranch_vccz K1_H0
    s_sub_u32 s48, s48, 1
    s_cbranch_scc1 K1_H0
    buffer_load_dwordx4 v[52:55], v6, s[20:23], s37 offen offset:0 sc1
    buffer_load_dwordx4 v[56:59], v6, s[20:23], s37 offen offset:1024 sc1
    buffer_load_dwordx4 v[60:63], v6, s[20:23], s37 offen offset:2048 sc1
    buffer_load_dwordx4 v[64:67], v6, s[20:23], s37 offen offset:3072 sc1
    buffer_load_dwordx4 v[48:51], v4, s[20:23], s35 offen sc1
    s_branch K1_G0
K1_H0:
    v_mul_f32 v48, s38, v48
    ds_write2_b32 v5, v48, v50 offset0:0 offset1:128
    v_add_f32 v52, v52, v56
    v_add_f32 v53, v53, v57
    v_add_f32 v60, v60, v64
    v_add_f32 v61, v61, v65
    v_add_f32 v52, v52, v60
    v_add_f32 v53, v53, v61
    s_nop 1
    v_permlane32_swap_b32 v52, v53
    v_add_f32 v52, v52, v53
    v_mov_b32 v53, v52
    s_nop 1
    v_permlane16_swap_b32 v52, v53
    v_add_f32 v52, v52, v53
    ds_write_b32 v37, v52
    s_waitcnt lgkmcnt(0)
    s_barrier
    s_mov_b32 s33, s34
    s_branch K2_LT
K1_L1:
    s_setprio 3
    v_lshrrev_b32 v3, 4, v1
    v_and_b32 v7, 15, v1
    v_mul_u32_u24 v5, 3840, v3
    v_lshlrev_b32 v6, 2, v3
    v_xor_b32 v6, v6, v7
    v_lshl_add_u32 v8, v6, 4, v5
    s_lshl_b32 s28, s25, 8
    v_add_u32 v8, s28, v8
    v_add_u32 v9, 14336, v8
    v_add_u32 v10, 28672, v8
    v_add_u32 v11, 43008, v8
    s_mul_i32 s30, s11, 3
    s_mov_b32 s31, s24
    s_mul_i32 s31, s31, 1
    s_add_u32 s30, s30, s31
    s_mul_i32 s31, s3, 0
    s_add_u32 s30, s30, s31
    s_mul_i32 s31, s30, 205
    s_lshr_b32 s31, s31, 11
    s_mul_i32 s31, s31, 10
    s_sub_u32 s30, s30, s31
    s_mul_i32 s30, s30, 245760
    s_waitcnt lgkmcnt(0)
    s_mov_b32 s12, s6
    s_mov_b32 s13, s7
    s_mov_b32 s14, 0x258000
    s_mov_b32 s15, 0x00020000
    s_mov_b32 m0, 16384
    s_add_u32 s31, s30, 0
    buffer_load_dwordx4 v8, s[12:15], s31 offen offset:0 lds
    buffer_load_dwordx4 v9, s[12:15], s31 offen offset:1024 lds
    buffer_load_dwordx4 v10, s[12:15], s31 offen offset:2048 lds
    buffer_load_dwordx4 v11, s[12:15], s31 offen offset:3072 lds
    s_mov_b32 m0, 20480
    s_add_u32 s31, s30, 61440
    buffer_load_dwordx4 v8, s[12:15], s31 offen offset:0 lds
    buffer_load_dwordx4 v9, s[12:15], s31 offen offset:1024 lds
    buffer_load_dwordx4 v10, s[12:15], s31 offen offset:2048 lds
    buffer_load_dwordx4 v11, s[12:15], s31 offen offset:3072 lds
    s_mov_b32 m0, 24576
    s_add_u32 s31, s30, 122880
    buffer_load_dwordx4 v8, s[12:15], s31 offen offset:0 lds
    buffer_load_dwordx4 v9, s[12:15], s31 offen offset:1024 lds
    buffer_load_dwordx4 v10, s[12:15], s31 offen offset:2048 lds
    buffer_load_dwordx4 v11, s[12:15], s31 offen offset:3072 lds
    s_mov_b32 m0, 28672
    s_add_u32 s31, s30, 184320
    buffer_load_dwordx4 v8, s[12:15], s31 offen offset:0 lds
    buffer_load_dwordx4 v9, s[12:15], s31 offen offset:1024 lds
    buffer_load_dwordx4 v10, s[12:15], s31 offen offset:2048 lds
    buffer_load_dwordx4 v11, s[12:15], s31 offen offset:3072 lds
    s_add_u32 s30, s30, 245760
    s_cmp_eq_u32 s30, 2457600
    s_cselect_b32 s30, 0, s30
    s_mov_b32 m0, 49152
    s_add_u32 s31, s30, 0
    buffer_load_dwordx4 v8, s[12:15], s31 offen offset:0 lds
    buffer_load_dwordx4 v9, s[12:15], s31 offen offset:1024 lds
    buffer_load_dwordx4 v10, s[12:15], s31 offen offset:2048 lds
    buffer_load_dwordx4 v11, s[12:15], s31 offen offset:3072 lds
    s_mov_b32 m0, 53248
    s_add_u32 s31, s30, 61440
    buffer_load_dwordx4 v8, s[12:15], s31 offen offset:0 lds
    buffer_load_dwordx4 v9, s[12:15], s31 offen offset:1024 lds
    buffer_load_dwordx4 v10, s[12:15], s31 offen offset:2048 lds
    buffer_load_dwordx4 v11, s[12:15], s31 offen offset:3072 lds
    s_mov_b32 m0, 57344
    s_add_u32 s31, s30, 122880
    buffer_load_dwordx4 v8, s[12:15], s31 offen offset:0 lds
    buffer_load_dwordx4 v9, s[12:15], s31 offen offset:1024 lds
    buffer_load_dwordx4 v10, s[12:15], s31 offen offset:2048 lds
    buffer_load_dwordx4 v11, s[12:15], s31 offen offset:3072 lds
    s_mov_b32 m0, 61440
    s_add_u32 s31, s30, 184320
    buffer_load_dwordx4 v8, s[12:15], s31 offen offset:0 lds
    buffer_load_dwordx4 v9, s[12:15], s31 offen offset:1024 lds
    buffer_load_dwordx4 v10, s[12:15], s31 offen offset:2048 lds
    buffer_load_dwordx4 v11, s[12:15], s31 offen offset:3072 lds
    s_mov_b32 s20, s8
    s_mov_b32 s21, s9
    s_mov_b32 s22, 0xe4c400
    s_mov_b32 s23, 0x00020000
    s_mov_b32 s40, s44
    s_mov_b32 s41, s45
    s_mov_b32 s42, 0x100
    s_mov_b32 s43, 0x00020000
    s_waitcnt vmcnt(16)
    s_barrier
    s_add_u32 s30, s30, 245760
    s_cmp_eq_u32 s30, 2457600
    s_cselect_b32 s30, 0, s30
    s_mov_b32 m0, 81920
    s_add_u32 s31, s30, 0
    buffer_load_dwordx4 v8, s[12:15], s31 offen offset:0 lds
    buffer_load_dwordx4 v9, s[12:15], s31 offen offset:1024 lds
    buffer_load_dwordx4 v10, s[12:15], s31 offen offset:2048 lds
    buffer_load_dwordx4 v11, s[12:15], s31 offen offset:3072 lds
    s_mov_b32 m0, 86016
    s_add_u32 s31, s30, 61440
    buffer_load_dwordx4 v8, s[12:15], s31 offen offset:0 lds
    buffer_load_dwordx4 v9, s[12:15], s31 offen offset:1024 lds
    buffer_load_dwordx4 v10, s[12:15], s31 offen offset:2048 lds
    buffer_load_dwordx4 v11, s[12:15], s31 offen offset:3072 lds
    s_mov_b32 m0, 90112
    s_add_u32 s31, s30, 122880
    buffer_load_dwordx4 v8, s[12:15], s31 offen offset:0 lds
    buffer_load_dwordx4 v9, s[12:15], s31 offen offset:1024 lds
    buffer_load_dwordx4 v10, s[12:15], s31 offen offset:2048 lds
    buffer_load_dwordx4 v11, s[12:15], s31 offen offset:3072 lds
    s_mov_b32 m0, 94208
    s_add_u32 s31, s30, 184320
    buffer_load_dwordx4 v8, s[12:15], s31 offen offset:0 lds
    buffer_load_dwordx4 v9, s[12:15], s31 offen offset:1024 lds
    buffer_load_dwordx4 v10, s[12:15], s31 offen offset:2048 lds
    buffer_load_dwordx4 v11, s[12:15], s31 offen offset:3072 lds
    s_waitcnt vmcnt(16)
    s_barrier
    s_add_u32 s30, s30, 245760
    s_cmp_eq_u32 s30, 2457600
    s_cselect_b32 s30, 0, s30
    s_mov_b32 m0, 114688
    s_add_u32 s31, s30, 0
    buffer_load_dwordx4 v8, s[12:15], s31 offen offset:0 lds
    buffer_load_dwordx4 v9, s[12:15], s31 offen offset:1024 lds
    buffer_load_dwordx4 v10, s[12:15], s31 offen offset:2048 lds
    buffer_load_dwordx4 v11, s[12:15], s31 offen offset:3072 lds
    s_mov_b32 m0, 118784
    s_add_u32 s31, s30, 61440
    buffer_load_dwordx4 v8, s[12:15], s31 offen offset:0 lds
    buffer_load_dwordx4 v9, s[12:15], s31 offen offset:1024 lds
    buffer_load_dwordx4 v10, s[12:15], s31 offen offset:2048 lds
    buffer_load_dwordx4 v11, s[12:15], s31 offen offset:3072 lds
    s_mov_b32 m0, 122880
    s_add_u32 s31, s30, 122880
    buffer_load_dwordx4 v8, s[12:15], s31 offen offset:0 lds
    buffer_load_dwordx4 v9, s[12:15], s31 offen offset:1024 lds
    buffer_load_dwordx4 v10, s[12:15], s31 offen offset:2048 lds
    buffer_load_dwordx4 v11, s[12:15], s31 offen offset:3072 lds
    s_mov_b32 m0, 126976
    s_add_u32 s31, s30, 184320
    buffer_load_dwordx4 v8, s[12:15], s31 offen offset:0 lds
    buffer_load_dwordx4 v9, s[12:15], s31 offen offset:1024 lds
    buffer_load_dwordx4 v10, s[12:15], s31 offen offset:2048 lds
    buffer_load_dwordx4 v11, s[12:15], s31 offen offset:3072 lds
    s_waitcnt vmcnt(16)
    s_barrier
    s_add_u32 s30, s30, 245760
    s_cmp_eq_u32 s30, 2457600
    s_cselect_b32 s30, 0, s30
    s_mov_b32 m0, 16384
    s_add_u32 s31, s30, 0
    buffer_load_dwordx4 v8, s[12:15], s31 offen offset:0 lds
    buffer_load_dwordx4 v9, s[12:15], s31 offen offset:1024 lds
    buffer_load_dwordx4 v10, s[12:15], s31 offen offset:2048 lds
    buffer_load_dwordx4 v11, s[12:15], s31 offen offset:3072 lds
    s_mov_b32 m0, 20480
    s_add_u32 s31, s30, 61440
    buffer_load_dwordx4 v8, s[12:15], s31 offen offset:0 lds
    buffer_load_dwordx4 v9, s[12:15], s31 offen offset:1024 lds
    buffer_load_dwordx4 v10, s[12:15], s31 offen offset:2048 lds
    buffer_load_dwordx4 v11, s[12:15], s31 offen offset:3072 lds
    s_mov_b32 m0, 24576
    s_add_u32 s31, s30, 122880
    buffer_load_dwordx4 v8, s[12:15], s31 offen offset:0 lds
    buffer_load_dwordx4 v9, s[12:15], s31 offen offset:1024 lds
    buffer_load_dwordx4 v10, s[12:15], s31 offen offset:2048 lds
    buffer_load_dwordx4 v11, s[12:15], s31 offen offset:3072 lds
    s_mov_b32 m0, 28672
    s_add_u32 s31, s30, 184320
    buffer_load_dwordx4 v8, s[12:15], s31 offen offset:0 lds
    buffer_load_dwordx4 v9, s[12:15], s31 offen offset:1024 lds
    buffer_load_dwordx4 v10, s[12:15], s31 offen offset:2048 lds
    buffer_load_dwordx4 v11, s[12:15], s31 offen offset:3072 lds
    s_waitcnt vmcnt(16)
    s_barrier
    s_add_u32 s30, s30, 245760
    s_cmp_eq_u32 s30, 2457600
    s_cselect_b32 s30, 0, s30
    s_mov_b32 m0, 49152
    s_add_u32 s31, s30, 0
    buffer_load_dwordx4 v8, s[12:15], s31 offen offset:0 lds
    buffer_load_dwordx4 v9, s[12:15], s31 offen offset:1024 lds
    buffer_load_dwordx4 v10, s[12:15], s31 offen offset:2048 lds
    buffer_load_dwordx4 v11, s[12:15], s31 offen offset:3072 lds
    s_mov_b32 m0, 53248
    s_add_u32 s31, s30, 61440
    buffer_load_dwordx4 v8, s[12:15], s31 offen offset:0 lds
    buffer_load_dwordx4 v9, s[12:15], s31 offen offset:1024 lds
    buffer_load_dwordx4 v10, s[12:15], s31 offen offset:2048 lds
    buffer_load_dwordx4 v11, s[12:15], s31 offen offset:3072 lds
    s_mov_b32 m0, 57344
    s_add_u32 s31, s30, 122880
    buffer_load_dwordx4 v8, s[12:15], s31 offen offset:0 lds
    buffer_load_dwordx4 v9, s[12:15], s31 offen offset:1024 lds
    buffer_load_dwordx4 v10, s[12:15], s31 offen offset:2048 lds
    buffer_load_dwordx4 v11, s[12:15], s31 offen offset:3072 lds
    s_mov_b32 m0, 61440
    s_add_u32 s31, s30, 184320
    buffer_load_dwordx4 v8, s[12:15], s31 offen offset:0 lds
    buffer_load_dwordx4 v9, s[12:15], s31 offen offset:1024 lds
    buffer_load_dwordx4 v10, s[12:15], s31 offen offset:2048 lds
    buffer_load_dwordx4 v11, s[12:15], s31 offen offset:3072 lds
    s_waitcnt vmcnt(16)
    s_barrier
    s_add_u32 s30, s30, 245760
    s_cmp_eq_u32 s30, 2457600
    s_cselect_b32 s30, 0, s30
    s_mov_b32 m0, 81920
    s_add_u32 s31, s30, 0
    buffer_load_dwordx4 v8, s[12:15], s31 offen offset:0 lds
    buffer_load_dwordx4 v9, s[12:15], s31 offen offset:1024 lds
    buffer_load_dwordx4 v10, s[12:15], s31 offen offset:2048 lds
    buffer_load_dwordx4 v11, s[12:15], s31 offen offset:3072 lds
    s_mov_b32 m0, 86016
    s_add_u32 s31, s30, 61440
    buffer_load_dwordx4 v8, s[12:15], s31 offen offset:0 lds
    buffer_load_dwordx4 v9, s[12:15], s31 offen offset:1024 lds
    buffer_load_dwordx4 v10, s[12:15], s31 offen offset:2048 lds
    buffer_load_dwordx4 v11, s[12:15], s31 offen offset:3072 lds
    s_mov_b32 m0, 90112
    s_add_u32 s31, s30, 122880
    buffer_load_dwordx4 v8, s[12:15], s31 offen offset:0 lds
    buffer_load_dwordx4 v9, s[12:15], s31 offen offset:1024 lds
    buffer_load_dwordx4 v10, s[12:15], s31 offen offset:2048 lds
    buffer_load_dwordx4 v11, s[12:15], s31 offen offset:3072 lds
    s_mov_b32 m0, 94208
    s_add_u32 s31, s30, 184320
    buffer_load_dwordx4 v8, s[12:15], s31 offen offset:0 lds
    buffer_load_dwordx4 v9, s[12:15], s31 offen offset:1024 lds
    buffer_load_dwordx4 v10, s[12:15], s31 offen offset:2048 lds
    buffer_load_dwordx4 v11, s[12:15], s31 offen offset:3072 lds
    s_waitcnt vmcnt(16)
    s_barrier
    s_add_u32 s30, s30, 245760
    s_cmp_eq_u32 s30, 2457600
    s_cselect_b32 s30, 0, s30
    s_mov_b32 m0, 114688
    s_add_u32 s31, s30, 0
    buffer_load_dwordx4 v8, s[12:15], s31 offen offset:0 lds
    buffer_load_dwordx4 v9, s[12:15], s31 offen offset:1024 lds
    buffer_load_dwordx4 v10, s[12:15], s31 offen offset:2048 lds
    buffer_load_dwordx4 v11, s[12:15], s31 offen offset:3072 lds
    s_mov_b32 m0, 118784
    s_add_u32 s31, s30, 61440
    buffer_load_dwordx4 v8, s[12:15], s31 offen offset:0 lds
    buffer_load_dwordx4 v9, s[12:15], s31 offen offset:1024 lds
    buffer_load_dwordx4 v10, s[12:15], s31 offen offset:2048 lds
    buffer_load_dwordx4 v11, s[12:15], s31 offen offset:3072 lds
    s_mov_b32 m0, 122880
    s_add_u32 s31, s30, 122880
    buffer_load_dwordx4 v8, s[12:15], s31 offen offset:0 lds
    buffer_load_dwordx4 v9, s[12:15], s31 offen offset:1024 lds
    buffer_load_dwordx4 v10, s[12:15], s31 offen offset:2048 lds
    buffer_load_dwordx4 v11, s[12:15], s31 offen offset:3072 lds
    s_mov_b32 m0, 126976
    s_add_u32 s31, s30, 184320
    buffer_load_dwordx4 v8, s[12:15], s31 offen offset:0 lds
    buffer_load_dwordx4 v9, s[12:15], s31 offen offset:1024 lds
    buffer_load_dwordx4 v10, s[12:15], s31 offen offset:2048 lds
    buffer_load_dwordx4 v11, s[12:15], s31 offen offset:3072 lds
    s_waitcnt vmcnt(16)
    s_barrier
    s_add_u32 s30, s30, 245760
    s_cmp_eq_u32 s30, 2457600
    s_cselect_b32 s30, 0, s30
    s_mov_b32 m0, 16384
    s_add_u32 s31, s30, 0
    buffer_load_dwordx4 v8, s[12:15], s31 offen offset:0 lds
    buffer_load_dwordx4 v9, s[12:15], s31 offen offset:1024 lds
    buffer_load_dwordx4 v10, s[12:15], s31 offen offset:2048 lds
    buffer_load_dwordx4 v11, s[12:15], s31 offen offset:3072 lds
    s_mov_b32 m0, 20480
    s_add_u32 s31, s30, 61440
    buffer_load_dwordx4 v8, s[12:15], s31 offen offset:0 lds
    buffer_load_dwordx4 v9, s[12:15], s31 offen offset:1024 lds
    buffer_load_dwordx4 v10, s[12:15], s31 offen offset:2048 lds
    buffer_load_dwordx4 v11, s[12:15], s31 offen offset:3072 lds
    s_mov_b32 m0, 24576
    s_add_u32 s31, s30, 122880
    buffer_load_dwordx4 v8, s[12:15], s31 offen offset:0 lds
    buffer_load_dwordx4 v9, s[12:15], s31 offen offset:1024 lds
    buffer_load_dwordx4 v10, s[12:15], s31 offen offset:2048 lds
    buffer_load_dwordx4 v11, s[12:15], s31 offen offset:3072 lds
    s_mov_b32 m0, 28672
    s_add_u32 s31, s30, 184320
    buffer_load_dwordx4 v8, s[12:15], s31 offen offset:0 lds
    buffer_load_dwordx4 v9, s[12:15], s31 offen offset:1024 lds
    buffer_load_dwordx4 v10, s[12:15], s31 offen offset:2048 lds
    buffer_load_dwordx4 v11, s[12:15], s31 offen offset:3072 lds
    buffer_load_dword v36, off, s[40:43], 0 sc1
    s_lshl_b32 s27, s25, 14
    s_add_u32 s37, s27, 14059776
    v_lshlrev_b32 v6, 12, v3
    v_lshl_add_u32 v6, v7, 4, v6
    s_mov_b32 s28, 132224
    v_lshrrev_b32 v37, 5, v1
    v_lshl_add_u32 v37, v7, 1, v37
    v_lshl_add_u32 v37, v37, 2, s28
    s_lshl_b32 s27, s24, 11
    s_add_u32 s35, s27, 14027776
    v_lshlrev_b32 v4, 4, v1
    s_mov_b32 s28, 131328
    v_lshl_add_u32 v5, v1, 2, s28
    s_cmp_ge_u32 s25, 5
    s_cselect_b32 s38, 1.0, 0x3ea52b5c
    s_waitcnt vmcnt(17)
    s_barrier
    s_add_u32 s30, s30, 245760
    s_cmp_eq_u32 s30, 2457600
    s_cselect_b32 s30, 0, s30
    s_mov_b32 m0, 49152
    s_add_u32 s31, s30, 0
    buffer_load_dwordx4 v8, s[12:15], s31 offen offset:0 lds
    buffer_load_dwordx4 v9, s[12:15], s31 offen offset:1024 lds
    buffer_load_dwordx4 v10, s[12:15], s31 offen offset:2048 lds
    buffer_load_dwordx4 v11, s[12:15], s31 offen offset:3072 lds
    s_mov_b32 m0, 53248
    s_add_u32 s31, s30, 61440
    buffer_load_dwordx4 v8, s[12:15], s31 offen offset:0 lds
    buffer_load_dwordx4 v9, s[12:15], s31 offen offset:1024 lds
    buffer_load_dwordx4 v10, s[12:15], s31 offen offset:2048 lds
    buffer_load_dwordx4 v11, s[12:15], s31 offen offset:3072 lds
    s_mov_b32 m0, 57344
    s_add_u32 s31, s30, 122880
    buffer_load_dwordx4 v8, s[12:15], s31 offen offset:0 lds
    buffer_load_dwordx4 v9, s[12:15], s31 offen offset:1024 lds
    buffer_load_dwordx4 v10, s[12:15], s31 offen offset:2048 lds
    buffer_load_dwordx4 v11, s[12:15], s31 offen offset:3072 lds
    s_mov_b32 m0, 61440
    s_add_u32 s31, s30, 184320
    buffer_load_dwordx4 v8, s[12:15], s31 offen offset:0 lds
    buffer_load_dwordx4 v9, s[12:15], s31 offen offset:1024 lds
    buffer_load_dwordx4 v10, s[12:15], s31 offen offset:2048 lds
    buffer_load_dwordx4 v11, s[12:15], s31 offen offset:3072 lds
    s_waitcnt vmcnt(16)
    v_readfirstlane_b32 s34, v36
    s_mov_b32 s48, 262144
    s_cmp_lg_u32 s34, 0
    s_cbranch_scc1 K1_N11
K1_N10:
    s_sub_u32 s48, s48, 1
    s_cbranch_scc1 K1_N11
    buffer_load_dword v36, off, s[40:43], 0 sc1
    s_waitcnt vmcnt(0)
    v_readfirstlane_b32 s34, v36
    s_cmp_eq_u32 s34, 0
    s_cbranch_scc1 K1_N10
K1_N11:
    buffer_load_dwordx4 v[52:55], v6, s[20:23], s37 offen offset:0 sc1
    buffer_load_dwordx4 v[56:59], v6, s[20:23], s37 offen offset:1024 sc1
    buffer_load_dwordx4 v[60:63], v6, s[20:23], s37 offen offset:2048 sc1
    buffer_load_dwordx4 v[64:67], v6, s[20:23], s37 offen offset:3072 sc1
    buffer_load_dwordx4 v[48:51], v4, s[20:23], s35 offen sc1
    s_barrier
    s_waitcnt vmcnt(5)
    s_barrier
K1_G1:
    s_waitcnt vmcnt(0)
    v_cmp_ne_u32 vcc, s34, v49
    v_cmp_ne_u32 s[46:47], s34, v51
    s_or_b64 vcc, vcc, s[46:47]
    v_cmp_ne_u32 s[46:47], s34, v54
    s_or_b64 vcc, vcc, s[46:47]
    v_cmp_ne_u32 s[46:47], s34, v55
    s_or_b64 vcc, vcc, s[46:47]
    v_cmp_ne_u32 s[46:47], s34, v58
    s_or_b64 vcc, vcc, s[46:47]
    v_cmp_ne_u32 s[46:47], s34, v59
    s_or_b64 vcc, vcc, s[46:47]
    v_cmp_ne_u32 s[46:47], s34, v62
    s_or_b64 vcc, vcc, s[46:47]
    v_cmp_ne_u32 s[46:47], s34, v63
    s_or_b64 vcc, vcc, s[46:47]
    v_cmp_ne_u32 s[46:47], s34, v66
    s_or_b64 vcc, vcc, s[46:47]
    v_cmp_ne_u32 s[46:47], s34, v67
    s_or_b64 vcc, vcc, s[46:47]
    s_cbranch_vccz K1_H1
    s_sub_u32 s48, s48, 1
    s_cbranch_scc1 K1_H1
    buffer_load_dwordx4 v[52:55], v6, s[20:23], s37 offen offset:0 sc1
    buffer_load_dwordx4 v[56:59], v6, s[20:23], s37 offen offset:1024 sc1
    buffer_load_dwordx4 v[60:63], v6, s[20:23], s37 offen offset:2048 sc1
    buffer_load_dwordx4 v[64:67], v6, s[20:23], s37 offen offset:3072 sc1
    buffer_load_dwordx4 v[48:51], v4, s[20:23], s35 offen sc1
    s_branch K1_G1
K1_H1:
    v_mul_f32 v48, s38, v48
    ds_write2_b32 v5, v48, v50 offset0:0 offset1:128
    v_add_f32 v52, v52, v56
    v_add_f32 v53, v53, v57
    v_add_f32 v60, v60, v64
    v_add_f32 v61, v61, v65
    v_add_f32 v52, v52, v60
    v_add_f32 v53, v53, v61
    s_nop 1
    v_permlane32_swap_b32 v52, v53
    v_add_f32 v52, v52, v53
    v_mov_b32 v53, v52
    s_nop 1
    v_permlane16_swap_b32 v52, v53
    v_add_f32 v52, v52, v53
    ds_write_b32 v37, v52
    s_waitcnt lgkmcnt(0)
    s_barrier
    s_mov_b32 s33, s34
    s_branch K2_LT
K1_L2:
    s_cmp_eq_u32 s26, 7
    s_cbranch_scc1 K1_L3
    v_lshrrev_b32 v3, 4, v1
    v_and_b32 v7, 15, v1
    s_lshl_b32 s27, s24, 7
    s_lshl_b32 s28, s25, 3
    s_add_u32 s27, s27, s28
    v_add_u32 v2, s27, v3
    v_mul_u32_u24 v4, 1280, v2
    v_lshl_add_u32 v38, v7, 4, v4
    v_add_u32 v39, 5120, v38
    s_waitcnt lgkmcnt(0)
    s_mov_b32 s12, s4
    s_mov_b32 s13, s5
    s_mov_b32 s14, 0x280000
    s_mov_b32 s15, 0x00020000
    v_mov_b32 v40, 0
    v_mov_b32 v41, 0
    v_mov_b32 v42, 0
    v_mov_b32 v43, 0
    v_mov_b32 v44, 163776
    ds_write_b128 v44, v[40:43]
    ds_write_b32 v44, v40 offset:16
    buffer_load_dwordx4 v[16:19], v38, s[12:15], 0 offen offset:0
    buffer_load_dwordx4 v[20:23], v38, s[12:15], 0 offen offset:256
    buffer_load_dwordx4 v[24:27], v38, s[12:15], 0 offen offset:512
    buffer_load_dwordx4 v[28:31], v38, s[12:15], 0 offen offset:768
    buffer_load_dwordx4 v[32:35], v38, s[12:15], 0 offen offset:1024
    buffer_load_dwordx4 v[76:79], v39, s[12:15], 0 offen offset:0
    buffer_load_dwordx4 v[80:83], v39, s[12:15], 0 offen offset:256
    buffer_load_dwordx4 v[84:87], v39, s[12:15], 0 offen offset:512
    buffer_load_dwordx4 v[88:91], v39, s[12:15], 0 offen offset:768
    buffer_load_dwordx4 v[92:95], v39, s[12:15], 0 offen offset:1024
    s_mov_b32 s20, s8
    s_mov_b32 s21, s9
    s_mov_b32 s22, 0xe4c400
    s_mov_b32 s23, 0x00020000
    s_mov_b32 s40, s44
    s_mov_b32 s41, s45
    s_mov_b32 s42, 0x100
    s_mov_b32 s43, 0x00020000
    v_lshlrev_b32 v2, 4, v2
    v_lshl_or_b32 v2, v7, 28, v2
    s_mov_b32 s36, 14026752
    s_lshl_b32 s27, s25, 14
    s_add_u32 s37, s27, 14060032
    v_lshlrev_b32 v6, 12, v3
    v_lshl_add_u32 v6, v7, 4, v6
    s_mov_b32 s28, 132352
    v_lshrrev_b32 v37, 5, v1
    v_lshl_add_u32 v37, v7, 1, v37
    v_lshl_add_u32 v37, v37, 2, s28
    s_waitcnt lgkmcnt(0)
    s_barrier
    buffer_load_dword v36, off, s[40:43], 0 sc1
    s_barrier
    s_waitcnt vmcnt(0)
    v_readfirstlane_b32 s34, v36
    s_mov_b32 s48, 262144
    s_cmp_lg_u32 s34, 0
    s_cbranch_scc1 K1_N21
K1_N20:
    s_sub_u32 s48, s48, 1
    s_cbranch_scc1 K1_N21
    buffer_load_dword v36, off, s[40:43], 0 sc1
    s_waitcnt vmcnt(0)
    v_readfirstlane_b32 s34, v36
    s_cmp_eq_u32 s34, 0
    s_cbranch_scc1 K1_N20
K1_N21:
    v_lshlrev_b32 v40, 16, v16
    v_and_b32 v16, 0xffff0000, v16
    v_mul_f32 v41, v40, v40
    v_add_f32 v40, v40, v16
    v_fma_f32 v41, v16, v16, v41
    v_lshlrev_b32 v42, 16, v17
    v_and_b32 v17, 0xffff0000, v17
    v_add_f32 v40, v40, v42
    v_fma_f32 v41, v42, v42, v41
    v_add_f32 v40, v40, v17
    v_fma_f32 v41, v17, v17, v41
    v_lshlrev_b32 v42, 16, v18
    v_and_b32 v18, 0xffff0000, v18
    v_add_f32 v40, v40, v42
    v_fma_f32 v41, v42, v42, v41
    v_add_f32 v40, v40, v18
    v_fma_f32 v41, v18, v18, v41
    v_lshlrev_b32 v42, 16, v19
    v_and_b32 v19, 0xffff0000, v19
    v_add_f32 v40, v40, v42
    v_fma_f32 v41, v42, v42, v41
    v_add_f32 v40, v40, v19
    v_fma_f32 v41, v19, v19, v41
    v_lshlrev_b32 v42, 16, v20
    v_and_b32 v20, 0xffff0000, v20
    v_add_f32 v40, v40, v42
    v_fma_f32 v41, v42, v42, v41
    v_add_f32 v40, v40, v20
    v_fma_f32 v41, v20, v20, v41
    v_lshlrev_b32 v42, 16, v21
    v_and_b32 v21, 0xffff0000, v21
    v_add_f32 v40, v40, v42
    v_fma_f32 v41, v42, v42, v41
    v_add_f32 v40, v40, v21
    v_fma_f32 v41, v21, v21, v41
    v_lshlrev_b32 v42, 16, v22
    v_and_b32 v22, 0xffff0000, v22
    v_add_f32 v40, v40, v42
    v_fma_f32 v41, v42, v42, v41
    v_add_f32 v40, v40, v22
    v_fma_f32 v41, v22, v22, v41
    v_lshlrev_b32 v42, 16, v23
    v_and_b32 v23, 0xffff0000, v23
    v_add_f32 v40, v40, v42
    v_fma_f32 v41, v42, v42, v41
    v_add_f32 v40, v40, v23
    v_fma_f32 v41, v23, v23, v41
    v_lshlrev_b32 v42, 16, v24
    v_and_b32 v24, 0xffff0000, v24
    v_add_f32 v40, v40, v42
    v_fma_f32 v41, v42, v42, v41
    v_add_f32 v40, v40, v24
    v_fma_f32 v41, v24, v24, v41
    v_lshlrev_b32 v42, 16, v25
    v_and_b32 v25, 0xffff0000, v25
    v_add_f32 v40, v40, v42
    v_fma_f32 v41, v42, v42, v41
    v_add_f32 v40, v40, v25
    v_fma_f32 v41, v25, v25, v41
    v_lshlrev_b32 v42, 16, v26
    v_and_b32 v26, 0xffff0000, v26
    v_add_f32 v40, v40, v42
    v_fma_f32 v41, v42, v42, v41
    v_add_f32 v40, v40, v26
    v_fma_f32 v41, v26, v26, v41
    v_lshlrev_b32 v42, 16, v27
    v_and_b32 v27, 0xffff0000, v27
    v_add_f32 v40, v40, v42
    v_fma_f32 v41, v42, v42, v41
    v_add_f32 v40, v40, v27
    s_barrier
    v_fma_f32 v41, v27, v27, v41
    v_lshlrev_b32 v42, 16, v28
    v_and_b32 v28, 0xffff0000, v28
    v_add_f32 v40, v40, v42
    v_fma_f32 v41, v42, v42, v41
    v_add_f32 v40, v40, v28
    v_fma_f32 v41, v28, v28, v41
    v_lshlrev_b32 v42, 16, v29
    v_and_b32 v29, 0xffff0000, v29
    v_add_f32 v40, v40, v42
    v_fma_f32 v41, v42, v42, v41
    v_add_f32 v40, v40, v29
    v_fma_f32 v41, v29, v29, v41
    v_lshlrev_b32 v42, 16, v30
    v_and_b32 v30, 0xffff0000, v30
    v_add_f32 v40, v40, v42
    v_fma_f32 v41, v42, v42, v41
    v_add_f32 v40, v40, v30
    v_fma_f32 v41, v30, v30, v41
    v_lshlrev_b32 v42, 16, v31
    v_and_b32 v31, 0xffff0000, v31
    v_add_f32 v40, v40, v42
    v_fma_f32 v41, v42, v42, v41
    v_add_f32 v40, v40, v31
    v_fma_f32 v41, v31, v31, v41
    v_lshlrev_b32 v42, 16, v32
    v_and_b32 v32, 0xffff0000, v32
    v_add_f32 v40, v40, v42
    v_fma_f32 v41, v42, v42, v41
    v_add_f32 v40, v40, v32
    v_fma_f32 v41, v32, v32, v41
    v_lshlrev_b32 v42, 16, v33
    v_and_b32 v33, 0xffff0000, v33
    v_add_f32 v40, v40, v42
    v_fma_f32 v41, v42, v42, v41
    v_add_f32 v40, v40, v33
    v_fma_f32 v41, v33, v33, v41
    v_lshlrev_b32 v42, 16, v34
    v_and_b32 v34, 0xffff0000, v34
    v_add_f32 v40, v40, v42
    v_fma_f32 v41, v42, v42, v41
    v_add_f32 v40, v40, v34
    v_fma_f32 v41, v34, v34, v41
    v_lshlrev_b32 v42, 16, v35
    v_and_b32 v35, 0xffff0000, v35
    v_add_f32 v40, v40, v42
    v_fma_f32 v41, v42, v42, v41
    v_add_f32 v40, v40, v35
    v_fma_f32 v41, v35, v35, v41
    s_nop 0
    v_add_f32_dpp v40, v40, v40 row_ror:8 row_mask:0xf bank_mask:0xf
    v_add_f32_dpp v41, v41, v41 row_ror:8 row_mask:0xf bank_mask:0xf
    s_nop 0
    v_add_f32_dpp v40, v40, v40 row_ror:4 row_mask:0xf bank_mask:0xf
    v_add_f32_dpp v41, v41, v41 row_ror:4 row_mask:0xf bank_mask:0xf
    s_nop 0
    v_add_f32_dpp v40, v40, v40 row_ror:2 row_mask:0xf bank_mask:0xf
    v_add_f32_dpp v41, v41, v41 row_ror:2 row_mask:0xf bank_mask:0xf
    s_nop 0
    v_add_f32_dpp v40, v40, v40 row_ror:1 row_mask:0xf bank_mask:0xf
    v_add_f32_dpp v41, v41, v41 row_ror:1 row_mask:0xf bank_mask:0xf
    v_mul_f32 v46, 0xbacccccd, v40
    v_mul_f32 v41, 0x3acccccd, v41
    v_fma_f32 v41, -v46, v46, v41
    v_max_f32 v41, 0, v41
    v_add_f32 v41, 0x3727c5ac, v41
    v_rsq_f32 v44, v41
    v_mov_b32 v45, s34
    v_mov_b32 v47, s34
    buffer_store_dwordx4 v[44:47], v2, s[20:23], s36 offen offset:0 sc1
    s_nop 1
    v_lshlrev_b32 v40, 16, v76
    s_barrier
    v_and_b32 v76, 0xffff0000, v76
    v_mul_f32 v41, v40, v40
    v_add_f32 v40, v40, v76
    v_fma_f32 v41, v76, v76, v41
    v_lshlrev_b32 v42, 16, v77
    v_and_b32 v77, 0xffff0000, v77
    v_add_f32 v40, v40, v42
    v_fma_f32 v41, v42, v42, v41
    v_add_f32 v40, v40, v77
    v_fma_f32 v41, v77, v77, v41
    v_lshlrev_b32 v42, 16, v78
    v_and_b32 v78, 0xffff0000, v78
    v_add_f32 v40, v40, v42
    v_fma_f32 v41, v42, v42, v41
    v_add_f32 v40, v40, v78
    v_fma_f32 v41, v78, v78, v41
    v_lshlrev_b32 v42, 16, v79
    v_and_b32 v79, 0xffff0000, v79
    v_add_f32 v40, v40, v42
    v_fma_f32 v41, v42, v42, v41
    v_add_f32 v40, v40, v79
    v_fma_f32 v41, v79, v79, v41
    v_lshlrev_b32 v42, 16, v80
    v_and_b32 v80, 0xffff0000, v80
    v_add_f32 v40, v40, v42
    v_fma_f32 v41, v42, v42, v41
    v_add_f32 v40, v40, v80
    v_fma_f32 v41, v80, v80, v41
    v_lshlrev_b32 v42, 16, v81
    v_and_b32 v81, 0xffff0000, v81
    v_add_f32 v40, v40, v42
    v_fma_f32 v41, v42, v42, v41
    v_add_f32 v40, v40, v81
    v_fma_f32 v41, v81, v81, v41
    v_lshlrev_b32 v42, 16, v82
    v_and_b32 v82, 0xffff0000, v82
    v_add_f32 v40, v40, v42
    v_fma_f32 v41, v42, v42, v41
    v_add_f32 v40, v40, v82
    v_fma_f32 v41, v82, v82, v41
    v_lshlrev_b32 v42, 16, v83
    v_and_b32 v83, 0xffff0000, v83
    v_add_f32 v40, v40, v42
    v_fma_f32 v41, v42, v42, v41
    v_add_f32 v40, v40, v83
    v_fma_f32 v41, v83, v83, v41
    v_lshlrev_b32 v42, 16, v84
    v_and_b32 v84, 0xffff0000, v84
    v_add_f32 v40, v40, v42
    v_fma_f32 v41, v42, v42, v41
    v_add_f32 v40, v40, v84
    v_fma_f32 v41, v84, v84, v41
    v_lshlrev_b32 v42, 16, v85
    v_and_b32 v85, 0xffff0000, v85
    v_add_f32 v40, v40, v42
    v_fma_f32 v41, v42, v42, v41
    v_add_f32 v40, v40, v85
    v_fma_f32 v41, v85, v85, v41
    v_lshlrev_b32 v42, 16, v86
    v_and_b32 v86, 0xffff0000, v86
    v_add_f32 v40, v40, v42
    v_fma_f32 v41, v42, v42, v41
    v_add_f32 v40, v40, v86
    v_fma_f32 v41, v86, v86, v41
    v_lshlrev_b32 v42, 16, v87
    v_and_b32 v87, 0xffff0000, v87
    v_add_f32 v40, v40, v42
    v_fma_f32 v41, v42, v42, v41
    v_add_f32 v40, v40, v87
    s_barrier
    v_fma_f32 v41, v87, v87, v41
    v_lshlrev_b32 v42, 16, v88
    v_and_b32 v88, 0xffff0000, v88
    v_add_f32 v40, v40, v42
    v_fma_f32 v41, v42, v42, v41
    v_add_f32 v40, v40, v88
    v_fma_f32 v41, v88, v88, v41
    v_lshlrev_b32 v42, 16, v89
    v_and_b32 v89, 0xffff0000, v89
    v_add_f32 v40, v40, v42
    v_fma_f32 v41, v42, v42, v41
    v_add_f32 v40, v40, v89
    v_fma_f32 v41, v89, v89, v41
    v_lshlrev_b32 v42, 16, v90
    v_and_b32 v90, 0xffff0000, v90
    v_add_f32 v40, v40, v42
    v_fma_f32 v41, v42, v42, v41
    v_add_f32 v40, v40, v90
    v_fma_f32 v41, v90, v90, v41
    v_lshlrev_b32 v42, 16, v91
    v_and_b32 v91, 0xffff0000, v91
    v_add_f32 v40, v40, v42
    v_fma_f32 v41, v42, v42, v41
    v_add_f32 v40, v40, v91
    v_fma_f32 v41, v91, v91, v41
    v_lshlrev_b32 v42, 16, v92
    v_and_b32 v92, 0xffff0000, v92
    v_add_f32 v40, v40, v42
    v_fma_f32 v41, v42, v42, v41
    v_add_f32 v40, v40, v92
    v_fma_f32 v41, v92, v92, v41
    v_lshlrev_b32 v42, 16, v93
    v_and_b32 v93, 0xffff0000, v93
    v_add_f32 v40, v40, v42
    v_fma_f32 v41, v42, v42, v41
    v_add_f32 v40, v40, v93
    v_fma_f32 v41, v93, v93, v41
    v_lshlrev_b32 v42, 16, v94
    v_and_b32 v94, 0xffff0000, v94
    v_add_f32 v40, v40, v42
    v_fma_f32 v41, v42, v42, v41
    v_add_f32 v40, v40, v94
    v_fma_f32 v41, v94, v94, v41
    v_lshlrev_b32 v42, 16, v95
    v_and_b32 v95, 0xffff0000, v95
    v_add_f32 v40, v40, v42
    v_fma_f32 v41, v42, v42, v41
    v_add_f32 v40, v40, v95
    v_fma_f32 v41, v95, v95, v41
    s_nop 0
    v_add_f32_dpp v40, v40, v40 row_ror:8 row_mask:0xf bank_mask:0xf
    v_add_f32_dpp v41, v41, v41 row_ror:8 row_mask:0xf bank_mask:0xf
    s_nop 0
    v_add_f32_dpp v40, v40, v40 row_ror:4 row_mask:0xf bank_mask:0xf
    v_add_f32_dpp v41, v41, v41 row_ror:4 row_mask:0xf bank_mask:0xf
    s_nop 0
    v_add_f32_dpp v40, v40, v40 row_ror:2 row_mask:0xf bank_mask:0xf
    v_add_f32_dpp v41, v41, v41 row_ror:2 row_mask:0xf bank_mask:0xf
    s_nop 0
    v_add_f32_dpp v40, v40, v40 row_ror:1 row_mask:0xf bank_mask:0xf
    v_add_f32_dpp v41, v41, v41 row_ror:1 row_mask:0xf bank_mask:0xf
    v_mul_f32 v46, 0xbacccccd, v40
    v_mul_f32 v41, 0x3acccccd, v41
    v_fma_f32 v41, -v46, v46, v41
    v_max_f32 v41, 0, v41
    v_add_f32 v41, 0x3727c5ac, v41
    v_rsq_f32 v44, v41
    v_mov_b32 v45, s34
    v_mov_b32 v47, s34
    buffer_store_dwordx4 v[44:47], v2, s[20:23], s36 offen offset:64 sc1
    s_nop 1
    s_barrier
    s_barrier
    s_lshl_b32 s50, s3, 2
    s_and_b32 s51, s10, 3
    s_add_u32 s50, s50, s51
    s_lshr_b32 s53, s50, 1
    s_mul_i32 s50, s50, 20
    s_add_u32 s51, s50, 19
    s_lshr_b32 s50, s50, 7
    s_lshr_b32 s51, s51, 7
    s_sub_u32 s51, s51, s50
    s_lshr_b32 s52, s10, 2
    s_lshl_b32 s52, s52, 1
    v_mov_b32 v220, 0
    v_lshrrev_b32 v214, 2, v1
    v_and_b32 v213, 3, v1
    v_and_b32 v215, 1, v214
    v_lshrrev_b32 v212, 1, v214
    v_mad_u32_u24 v212, v212, 5, 5
    v_cmp_eq_u32 vcc, 4, v214
    v_lshrrev_b32 v218, 1, v213
    v_and_b32 v217, 1, v213
    v_add_u32 v217, s52, v217
    v_cndmask_b32 v215, v215, v218, vcc
    v_cndmask_b32 v213, v213, v217, vcc
    v_cndmask_b32 v212, v212, v220, vcc
    v_mad_u32_u24 v212, v215, s51, v212
    v_add_u32 v212, s50, v212
    v_cmp_lt_u32 vcc, 4, v214
    v_mov_b32 v217, s53
    v_mov_b32 v218, 15
    v_cndmask_b32 v213, v213, v217, vcc
    v_cndmask_b32 v212, v212, v218, vcc
    v_lshl_add_u32 v212, v213, 4, v212
    v_lshlrev_b32 v212, 7, v212
    v_add_u32 v216, 14587904, v212
    v_bfe_u32 v215, v1, 4, 1
    v_lshrrev_b32 v212, 5, v1
    v_mad_u32_u24 v212, v212, 5, 5
    v_mad_u32_u24 v212, v215, s51, v212
    v_add_u32 v212, s50, v212
    v_and_b32 v213, 15, v1
    v_lshl_add_u32 v212, v213, 4, v212
    v_lshlrev_b32 v212, 7, v212
    v_add_u32 v217, 14587904, v212
    v_mov_b32 v212, 15
    v_and_b32 v213, 15, v1
    v_lshl_add_u32 v212, v213, 4, v212
    v_lshlrev_b32 v212, 7, v212
    v_add_u32 v218, 14587904, v212
    v_lshrrev_b32 v214, 2, v1
    v_and_b32 v213, 3, v1
    s_lshl_b32 s52, s3, 2
    v_add_u32 v213, s52, v213
    v_lshl_add_u32 v213, v213, 3, v214
    v_lshlrev_b32 v213, 7, v213
    v_add_u32 v213, 14587968, v213
    v_cmp_gt_u32 vcc, 32, v1
    s_nop 1
    v_cndmask_b32 v218, v218, v213, vcc
    s_barrier
    buffer_load_dwordx4 v[52:55], v6, s[20:23], s37 offen offset:0 sc1
    buffer_load_dwordx4 v[56:59], v6, s[20:23], s37 offen offset:1024 sc1
    buffer_load_dwordx4 v[60:63], v6, s[20:23], s37 offen offset:2048 sc1
    buffer_load_dwordx4 v[64:67], v6, s[20:23], s37 offen offset:3072 sc1
    s_barrier
    s_barrier
    buffer_load_dword v219, v216, s[20:23], 0 offen sc1
K1_G2:
    s_waitcnt vmcnt(0)
    s_mov_b64 vcc, 0
    v_cmp_ne_u32 s[46:47], s34, v54
    s_or_b64 vcc, vcc, s[46:47]
    v_cmp_ne_u32 s[46:47], s34, v55
    s_or_b64 vcc, vcc, s[46:47]
    v_cmp_ne_u32 s[46:47], s34, v58
    s_or_b64 vcc, vcc, s[46:47]
    v_cmp_ne_u32 s[46:47], s34, v59
    s_or_b64 vcc, vcc, s[46:47]
    v_cmp_ne_u32 s[46:47], s34, v62
    s_or_b64 vcc, vcc, s[46:47]
    v_cmp_ne_u32 s[46:47], s34, v63
    s_or_b64 vcc, vcc, s[46:47]
    v_cmp_ne_u32 s[46:47], s34, v66
    s_or_b64 vcc, vcc, s[46:47]
    v_cmp_ne_u32 s[46:47], s34, v67
    s_or_b64 vcc, vcc, s[46:47]
    s_cbranch_vccz K1_H2
    s_sub_u32 s48, s48, 1
    s_cbranch_scc1 K1_H2
    buffer_load_dwordx4 v[52:55], v6, s[20:23], s37 offen offset:0 sc1
    buffer_load_dwordx4 v[56:59], v6, s[20:23], s37 offen offset:1024 sc1
    buffer_load_dwordx4 v[60:63], v6, s[20:23], s37 offen offset:2048 sc1
    buffer_load_dwordx4 v[64:67], v6, s[20:23], s37 offen offset:3072 sc1
    s_branch K1_G2
K1_H2:
    v_mov_b32 v44, 163776
    v_mov_b32 v45, s34
    ds_write_b32 v44, v45 offset:12
    v_add_f32 v52, v52, v56
    v_add_f32 v53, v53, v57
    v_add_f32 v60, v60, v64
    v_add_f32 v61, v61, v65
    v_add_f32 v52, v52, v60
    v_add_f32 v53, v53, v61
    s_nop 1
    v_permlane32_swap_b32 v52, v53
    v_add_f32 v52, v52, v53
    v_mov_b32 v53, v52
    s_nop 1
    v_permlane16_swap_b32 v52, v53
    v_add_f32 v52, v52, v53
    ds_write_b32 v37, v52
    s_waitcnt lgkmcnt(0)
    s_barrier
    s_mov_b32 s33, s34
    s_branch K2_LP
K1_L3:
    v_lshrrev_b32 v3, 4, v1
    v_and_b32 v7, 15, v1
    s_mul_i32 s27, s24, 40*3840
    s_lshl_b32 s28, s25, 8
    s_add_u32 s27, s27, s28
    v_lshrrev_b32 v2, 3, v1
    v_mul_u32_u24 v4, 3840, v2
    v_and_b32 v5, 7, v1
    v_lshl_add_u32 v4, v5, 4, v4
    v_add_u32 v38, s27, v4
    s_waitcnt lgkmcnt(0)
    s_mov_b32 s12, s6
    s_mov_b32 s13, s7
    s_mov_b32 s14, 0x258000
    s_mov_b32 s15, 0x00020000
    s_mov_b32 s49, 0
    buffer_load_dwordx4 v[16:19], v38, s[12:15], s49 offen
    buffer_load_dwordx4 v[76:79], v38, s[12:15], s49 offen offset:128
    s_mov_b32 s49, 30720
    buffer_load_dwordx4 v[20:23], v38, s[12:15], s49 offen
    buffer_load_dwordx4 v[80:83], v38, s[12:15], s49 offen offset:128
    s_mov_b32 s49, 61440
    buffer_load_dwordx4 v[24:27], v38, s[12:15], s49 offen
    buffer_load_dwordx4 v[84:87], v38, s[12:15], s49 offen offset:128
    s_mov_b32 s49, 92160
    buffer_load_dwordx4 v[28:31], v38, s[12:15], s49 offen
    buffer_load_dwordx4 v[88:91], v38, s[12:15], s49 offen offset:128
    s_mov_b32 s49, 122880
    buffer_load_dwordx4 v[32:35], v38, s[12:15], s49 offen
    buffer_load_dwordx4 v[92:95], v38, s[12:15], s49 offen offset:128
    s_mov_b32 s20, s8
    s_mov_b32 s21, s9
    s_mov_b32 s22, 0xe4c400
    s_mov_b32 s23, 0x00020000
    s_mov_b32 s40, s44
    s_mov_b32 s41, s45
    s_mov_b32 s42, 0x100
    s_mov_b32 s43, 0x00020000
    v_lshrrev_b32 v4, 5, v1
    v_lshl_add_u32 v5, v5, 1, v4
    v_and_b32 v4, 1, v3
    v_lshl_add_u32 v5, v5, 1, v4
    v_lshlrev_b32 v5, 4, v5
    v_and_b32 v2, 1, v2
    v_lshl_or_b32 v2, v2, 31, v5
    s_lshl_b32 s27, s25, 14
    s_lshl_b32 s28, s24, 10
    s_add_u32 s27, s27, s28
    s_add_u32 s36, s27, 14059520
    s_lshl_b32 s27, s25, 14
    s_add_u32 s37, s27, 14060288
    v_lshlrev_b32 v6, 12, v3
    v_lshl_add_u32 v6, v7, 4, v6
    s_mov_b32 s28, 132480
    v_lshrrev_b32 v37, 5, v1
    v_lshl_add_u32 v37, v7, 1, v37
    v_lshl_add_u32 v37, v37, 2, s28
    s_barrier
    buffer_load_dword v36, off, s[40:43], 0 sc1
    s_barrier
    s_waitcnt vmcnt(0)
    v_readfirstlane_b32 s34, v36
    s_mov_b32 s48, 262144
    s_cmp_lg_u32 s34, 0
    s_cbranch_scc1 K1_N31
K1_N30:
    s_sub_u32 s48, s48, 1
    s_cbranch_scc1 K1_N31
    buffer_load_dword v36, off, s[40:43], 0 sc1
    s_waitcnt vmcnt(0)
    v_readfirstlane_b32 s34, v36
    s_cmp_eq_u32 s34, 0
    s_cbranch_scc1 K1_N30
K1_N31:
    v_lshlrev_b32 v40, 16, v16
    v_and_b32 v41, 0xffff0000, v16
    v_lshlrev_b32 v42, 16, v17
    v_and_b32 v43, 0xffff0000, v17
    v_lshlrev_b32 v44, 16, v18
    v_and_b32 v45, 0xffff0000, v18
    v_lshlrev_b32 v46, 16, v19
    v_and_b32 v47, 0xffff0000, v19
    v_lshlrev_b32 v48, 16, v20
    v_and_b32 v20, 0xffff0000, v20
    v_add_f32 v40, v40, v48
    v_add_f32 v41, v41, v20
    v_lshlrev_b32 v48, 16, v21
    v_and_b32 v21, 0xffff0000, v21
    v_add_f32 v42, v42, v48
    v_add_f32 v43, v43, v21
    v_lshlrev_b32 v48, 16, v22
    v_and_b32 v22, 0xffff0000, v22
    v_add_f32 v44, v44, v48
    v_add_f32 v45, v45, v22
    v_lshlrev_b32 v48, 16, v23
    v_and_b32 v23, 0xffff0000, v23
    v_add_f32 v46, v46, v48
    v_add_f32 v47, v47, v23
    v_lshlrev_b32 v48, 16, v24
    v_and_b32 v24, 0xffff0000, v24
    v_add_f32 v40, v40, v48
    v_add_f32 v41, v41, v24
    v_lshlrev_b32 v48, 16, v25
    v_and_b32 v25, 0xffff0000, v25
    v_add_f32 v42, v42, v48
    v_add_f32 v43, v43, v25
    v_lshlrev_b32 v48, 16, v26
    v_and_b32 v26, 0xffff0000, v26
    v_add_f32 v44, v44, v48
    v_add_f32 v45, v45, v26
    v_lshlrev_b32 v48, 16, v27
    v_and_b32 v27, 0xffff0000, v27
    v_add_f32 v46, v46, v48
    v_add_f32 v47, v47, v27
    v_lshlrev_b32 v48, 16, v28
    v_and_b32 v28, 0xffff0000, v28
    v_add_f32 v40, v40, v48
    v_add_f32 v41, v41, v28
    v_lshlrev_b32 v48, 16, v29
    v_and_b32 v29, 0xffff0000, v29
    s_barrier
    v_add_f32 v42, v42, v48
    v_add_f32 v43, v43, v29
    v_lshlrev_b32 v48, 16, v30
    v_and_b32 v30, 0xffff0000, v30
    v_add_f32 v44, v44, v48
    v_add_f32 v45, v45, v30
    v_lshlrev_b32 v48, 16, v31
    v_and_b32 v31, 0xffff0000, v31
    v_add_f32 v46, v46, v48
    v_add_f32 v47, v47, v31
    v_lshlrev_b32 v48, 16, v32
    v_and_b32 v32, 0xffff0000, v32
    v_add_f32 v40, v40, v48
    v_add_f32 v41, v41, v32
    v_lshlrev_b32 v48, 16, v33
    v_and_b32 v33, 0xffff0000, v33
    v_add_f32 v42, v42, v48
    v_add_f32 v43, v43, v33
    v_lshlrev_b32 v48, 16, v34
    v_and_b32 v34, 0xffff0000, v34
    v_add_f32 v44, v44, v48
    v_add_f32 v45, v45, v34
    v_lshlrev_b32 v48, 16, v35
    v_and_b32 v35, 0xffff0000, v35
    v_add_f32 v46, v46, v48
    v_add_f32 v47, v47, v35
    s_nop 1
    v_permlane32_swap_b32 v40, v44
    v_permlane32_swap_b32 v41, v45
    v_permlane32_swap_b32 v42, v46
    v_permlane32_swap_b32 v43, v47
    v_add_f32 v40, v40, v44
    v_add_f32 v41, v41, v45
    v_add_f32 v42, v42, v46
    v_add_f32 v43, v43, v47
    s_nop 0
    v_permlane16_swap_b32 v40, v42
    v_permlane16_swap_b32 v41, v43
    v_add_f32 v40, v40, v42
    v_add_f32 v41, v41, v43
    s_nop 0
    v_add_f32_dpp v40, v40, v40 row_ror:8 row_mask:0xf bank_mask:0xf
    v_add_f32_dpp v41, v41, v41 row_ror:8 row_mask:0xf bank_mask:0xf
    v_mov_b32 v42, s34
    v_mov_b32 v43, s34
    buffer_store_dwordx4 v[40:43], v2, s[20:23], s36 offen offset:0 sc1
    s_nop 1
    v_lshlrev_b32 v40, 16, v76
    s_barrier
    v_and_b32 v41, 0xffff0000, v76
    v_lshlrev_b32 v42, 16, v77
    v_and_b32 v43, 0xffff0000, v77
    v_lshlrev_b32 v44, 16, v78
    v_and_b32 v45, 0xffff0000, v78
    v_lshlrev_b32 v46, 16, v79
    v_and_b32 v47, 0xffff0000, v79
    v_lshlrev_b32 v48, 16, v80
    v_and_b32 v80, 0xffff0000, v80
    v_add_f32 v40, v40, v48
    v_add_f32 v41, v41, v80
    v_lshlrev_b32 v48, 16, v81
    v_and_b32 v81, 0xffff0000, v81
    v_add_f32 v42, v42, v48
    v_add_f32 v43, v43, v81
    v_lshlrev_b32 v48, 16, v82
    v_and_b32 v82, 0xffff0000, v82
    v_add_f32 v44, v44, v48
    v_add_f32 v45, v45, v82
    v_lshlrev_b32 v48, 16, v83
    v_and_b32 v83, 0xffff0000, v83
    v_add_f32 v46, v46, v48
    v_add_f32 v47, v47, v83
    v_lshlrev_b32 v48, 16, v84
    v_and_b32 v84, 0xffff0000, v84
    v_add_f32 v40, v40, v48
    v_add_f32 v41, v41, v84
    v_lshlrev_b32 v48, 16, v85
    v_and_b32 v85, 0xffff0000, v85
    v_add_f32 v42, v42, v48
    v_add_f32 v43, v43, v85
    v_lshlrev_b32 v48, 16, v86
    v_and_b32 v86, 0xffff0000, v86
    v_add_f32 v44, v44, v48
    v_add_f32 v45, v45, v86
    v_lshlrev_b32 v48, 16, v87
    v_and_b32 v87, 0xffff0000, v87
    v_add_f32 v46, v46, v48
    v_add_f32 v47, v47, v87
    v_lshlrev_b32 v48, 16, v88
    v_and_b32 v88, 0xffff0000, v88
    v_add_f32 v40, v40, v48
    v_add_f32 v41, v41, v88
    v_lshlrev_b32 v48, 16, v89
    v_and_b32 v89, 0xffff0000, v89
    s_barrier
    v_add_f32 v42, v42, v48
    v_add_f32 v43, v43, v89
    v_lshlrev_b32 v48, 16, v90
    v_and_b32 v90, 0xffff0000, v90
    v_add_f32 v44, v44, v48
    v_add_f32 v45, v45, v90
    v_lshlrev_b32 v48, 16, v91
    v_and_b32 v91, 0xffff0000, v91
    v_add_f32 v46, v46, v48
    v_add_f32 v47, v47, v91
    v_lshlrev_b32 v48, 16, v92
    v_and_b32 v92, 0xffff0000, v92
    v_add_f32 v40, v40, v48
    v_add_f32 v41, v41, v92
    v_lshlrev_b32 v48, 16, v93
    v_and_b32 v93, 0xffff0000, v93
    v_add_f32 v42, v42, v48
    v_add_f32 v43, v43, v93
    v_lshlrev_b32 v48, 16, v94
    v_and_b32 v94, 0xffff0000, v94
    v_add_f32 v44, v44, v48
    v_add_f32 v45, v45, v94
    v_lshlrev_b32 v48, 16, v95
    v_and_b32 v95, 0xffff0000, v95
    v_add_f32 v46, v46, v48
    v_add_f32 v47, v47, v95
    s_nop 1
    v_permlane32_swap_b32 v40, v44
    v_permlane32_swap_b32 v41, v45
    v_permlane32_swap_b32 v42, v46
    v_permlane32_swap_b32 v43, v47
    v_add_f32 v40, v40, v44
    v_add_f32 v41, v41, v45
    v_add_f32 v42, v42, v46
    v_add_f32 v43, v43, v47
    s_nop 0
    v_permlane16_swap_b32 v40, v42
    v_permlane16_swap_b32 v41, v43
    v_add_f32 v40, v40, v42
    v_add_f32 v41, v41, v43
    s_nop 0
    v_add_f32_dpp v40, v40, v40 row_ror:8 row_mask:0xf bank_mask:0xf
    v_add_f32_dpp v41, v41, v41 row_ror:8 row_mask:0xf bank_mask:0xf
    v_mov_b32 v42, s34
    v_mov_b32 v43, s34
    buffer_store_dwordx4 v[40:43], v2, s[20:23], s36 offen offset:512 sc1
    s_nop 1
    s_barrier
    s_barrier
    s_barrier
    buffer_load_dwordx4 v[52:55], v6, s[20:23], s37 offen offset:0 sc1
    buffer_load_dwordx4 v[56:59], v6, s[20:23], s37 offen offset:1024 sc1
    buffer_load_dwordx4 v[60:63], v6, s[20:23], s37 offen offset:2048 sc1
    buffer_load_dwordx4 v[64:67], v6, s[20:23], s37 offen offset:3072 sc1
    s_barrier
    s_barrier
K1_G3:
    s_waitcnt vmcnt(0)
    s_mov_b64 vcc, 0
    v_cmp_ne_u32 s[46:47], s34, v54
    s_or_b64 vcc, vcc, s[46:47]
    v_cmp_ne_u32 s[46:47], s34, v55
    s_or_b64 vcc, vcc, s[46:47]
    v_cmp_ne_u32 s[46:47], s34, v58
    s_or_b64 vcc, vcc, s[46:47]
    v_cmp_ne_u32 s[46:47], s34, v59
    s_or_b64 vcc, vcc, s[46:47]
    v_cmp_ne_u32 s[46:47], s34, v62
    s_or_b64 vcc, vcc, s[46:47]
    v_cmp_ne_u32 s[46:47], s34, v63
    s_or_b64 vcc, vcc, s[46:47]
    v_cmp_ne_u32 s[46:47], s34, v66
    s_or_b64 vcc, vcc, s[46:47]
    v_cmp_ne_u32 s[46:47], s34, v67
    s_or_b64 vcc, vcc, s[46:47]
    s_cbranch_vccz K1_H3
    s_sub_u32 s48, s48, 1
    s_cbranch_scc1 K1_H3
    buffer_load_dwordx4 v[52:55], v6, s[20:23], s37 offen offset:0 sc1
    buffer_load_dwordx4 v[56:59], v6, s[20:23], s37 offen offset:1024 sc1
    buffer_load_dwordx4 v[60:63], v6, s[20:23], s37 offen offset:2048 sc1
    buffer_load_dwordx4 v[64:67], v6, s[20:23], s37 offen offset:3072 sc1
    s_branch K1_G3
K1_H3:
    v_add_f32 v52, v52, v56
    v_add_f32 v53, v53, v57
    v_add_f32 v60, v60, v64
    v_add_f32 v61, v61, v65
    v_add_f32 v52, v52, v60
    v_add_f32 v53, v53, v61
    s_nop 1
    v_permlane32_swap_b32 v52, v53
    v_add_f32 v52, v52, v53
    v_mov_b32 v53, v52
    s_nop 1
    v_permlane16_swap_b32 v52, v53
    v_add_f32 v52, v52, v53
    ds_write_b32 v37, v52
    s_waitcnt lgkmcnt(0)
    s_barrier
    s_mov_b32 s33, s34
    s_branch K2_LT
K1_COMP:
    s_lshr_b32 s27, s26, 1
    s_and_b32 s28, s26, 1
    v_and_b32 v48, 31, v0
    v_bfe_u32 v49, v0, 5, 1
    v_bfe_u32 v50, v0, 1, 3
    v_xor_b32 v50, v50, v49
    v_lshlrev_b32 v50, 4, v50
    v_lshl_add_u32 v50, v48, 7, v50
    s_lshl_b32 s30, s27, 13
    s_lshl_b32 s31, s28, 12
    s_add_u32 s30, s30, s31
    v_add_u32 v2, s30, v50
    v_xor_b32 v3, 32, v2
    v_xor_b32 v4, 64, v2
    v_xor_b32 v5, 96, v2
    v_xor_b32 v6, 0x1000, v2
    v_xor_b32 v7, 0x1000, v3
    v_xor_b32 v8, 0x1000, v4
    v_xor_b32 v9, 0x1000, v5
    v_bfe_u32 v50, v0, 2, 2
    v_bfe_u32 v51, v0, 4, 1
    v_bfe_u32 v52, v0, 1, 1
    v_lshl_add_u32 v51, v51, 1, v52
    s_lshl_b32 s30, s28, 1
    s_add_u32 s30, s30, s27
    v_xor_b32 v52, s30, v50
    v_lshl_add_u32 v51, v52, 2, v51
    v_lshlrev_b32 v51, 4, v51
    v_lshl_add_u32 v51, v50, 8, v51
    v_lshl_add_u32 v51, v49, 11, v51
    v_and_b32 v52, 1, v0
    v_lshl_add_u32 v51, v52, 3, v51
    v_add_u32 v10, 0x4000, v51
    v_xor_b32 v11, 64, v10
    s_mov_b32 s33, 5
    s_lshl_b32 s34, s24, 1
    s_add_u32 s34, s34, s27
    v_mov_b32 v64, 0
    v_mov_b32 v65, 0
    v_mov_b32 v66, 0
    v_mov_b32 v67, 0
    v_mov_b32 v68, 0
    v_mov_b32 v69, 0
    v_mov_b32 v70, 0
    v_mov_b32 v71, 0
    v_mov_b32 v72, 0
    v_mov_b32 v73, 0
    v_mov_b32 v74, 0
    v_mov_b32 v75, 0
    v_mov_b32 v76, 0
    v_mov_b32 v77, 0
    v_mov_b32 v78, 0
    v_mov_b32 v79, 0
    v_mov_b32 v80, 0
    v_mov_b32 v81, 0
    v_mov_b32 v82, 0
    v_mov_b32 v83, 0
    v_mov_b32 v84, 0
    v_mov_b32 v85, 0
    v_mov_b32 v86, 0
    v_mov_b32 v87, 0
    v_mov_b32 v88, 0
    v_mov_b32 v89, 0
    v_mov_b32 v90, 0
    v_mov_b32 v91, 0
    v_mov_b32 v92, 0
    v_mov_b32 v93, 0
    v_mov_b32 v94, 0
    v_mov_b32 v95, 0
    v_mov_b32 v96, 0
    v_mov_b32 v97, 0
    v_mov_b32 v98, 0
    v_mov_b32 v99, 0
    v_mov_b32 v100, 0
    v_mov_b32 v101, 0
    v_mov_b32 v102, 0
    v_mov_b32 v103, 0
    v_mov_b32 v104, 0
    v_mov_b32 v105, 0
    v_mov_b32 v106, 0
    v_mov_b32 v107, 0
    v_mov_b32 v108, 0
    v_mov_b32 v109, 0
    v_mov_b32 v110, 0
    v_mov_b32 v111, 0
    v_mov_b32 v112, 0
    v_mov_b32 v113, 0
    v_mov_b32 v114, 0
    v_mov_b32 v115, 0
    v_mov_b32 v116, 0
    v_mov_b32 v117, 0
    v_mov_b32 v118, 0
    v_mov_b32 v119, 0
    v_mov_b32 v120, 0
    v_mov_b32 v121, 0
    v_mov_b32 v122, 0
    v_mov_b32 v123, 0
    v_mov_b32 v124, 0
    v_mov_b32 v125, 0
    v_mov_b32 v126, 0
    v_mov_b32 v127, 0
    s_waitcnt lgkmcnt(0)
    s_mov_b32 s20, s8
    s_mov_b32 s21, s9
    s_mov_b32 s22, 0xe4c400
    s_mov_b32 s23, 0x00020000
    s_or_b32 s30, s2, s26
    s_cmp_lg_u32 s30, 0
    s_cbranch_scc1 K1_NN
    s_memrealtime s[46:47]
    s_mov_b32 s40, s44
    s_mov_b32 s41, s45
    s_mov_b32 s42, 0x100
    s_mov_b32 s43, 0x00020000
    s_mov_b32 s30, 14018624
    s_waitcnt lgkmcnt(0)
    s_or_b32 s46, s46, 1
    s_mov_b64 exec, 1
    v_mov_b32 v50, s46
    buffer_store_dword v50, off, s[40:43], 0 sc1
    s_mov_b64 exec, -1
K1_NN:
    v_and_b32 v192, 31, v0
    v_bfe_u32 v193, v0, 5, 1
    v_and_b32 v184, 63, v0
    v_lshlrev_b32 v184, 4, v184
    v_lshlrev_b32 v194, 4, v192
    v_add_u32 v185, 2048, v194
    v_mul_u32_u24 v186, 336, v193
    v_add3_u32 v186, v186, v185, 0
    v_add_u32 v186, 512, v186
    v_lshl_add_u32 v187, v193, 3, v185
    v_lshl_or_b32 v185, v193, 30, v185
    v_add_u32 v194, 11, v192
    v_lshrrev_b32 v194, 5, v194
    v_lshl_or_b32 v186, v194, 30, v186
    v_lshrrev_b32 v194, 4, v192
    v_and_b32 v195, 15, v0
    v_lshlrev_b32 v195, 4, v195
    v_lshl_add_u32 v180, v194, 14, v195
    v_lshl_add_u32 v180, v193, 8, v180
    v_lshl_add_u32 v181, v194, 13, v195
    v_lshl_or_b32 v181, v193, 31, v181
    v_mov_b32 v191, 163776
    s_lshl_b32 s101, s3, 2
    s_and_b32 s46, s10, 3
    s_add_u32 s101, s101, s46
    s_mul_i32 s96, s101, 81920
    s_add_u32 s96, s96, 2621440
    s_lshr_b32 s46, s10, 2
    s_lshl_b32 s46, s46, 2
    s_add_u32 s46, s46, s26
    s_mul_i32 s97, s101, 81920
    s_mul_i32 s47, s46, 2560
    s_add_u32 s97, s97, s47
    s_mul_i32 s98, s46, 81920
    s_add_u32 s98, s98, 7868416
    s_lshl_b32 s47, s101, 8
    s_add_u32 s98, s98, s47
    s_add_u32 s99, s98, 65536
    s_add_u32 s98, s98, s47
    s_lshl_b32 s100, s24, 4
    s_add_u32 s100, s100, s25
    s_lshl_b32 s100, s100, 7
    s_add_u32 s100, s100, 14587904
    v_and_b32 v189, 7, v0
    v_lshlrev_b32 v189, 15, v189
    s_and_b32 s46, s101, 1
    s_lshl_b32 s46, s46, 2
    s_mul_i32 s47, s101, 320
    v_and_b32 v188, 0x13, v192
    v_and_b32 v194, 4, v192
    v_lshl_add_u32 v188, v194, 1, v188
    v_bfe_u32 v194, v192, 3, 1
    v_lshl_add_u32 v188, v194, 2, v188
    v_add_u32 v188, s46, v188
    v_subrev_u32 v194, 20, v188
    v_min_u32 v188, v188, v194
    v_lshl_add_u32 v188, v188, 4, s47
    v_mul_u32_u24 v194, 10240, v193
    v_add_u32 v188, v188, v194
    s_cmp_ge_u32 s25, 10
    s_cbranch_scc1 K1_V
    s_cmp_ge_u32 s25, 5
    s_mov_b32 s35, 81920
    s_mov_b32 s36, 2560
    s_cselect_b32 s37, 2621440, 0
    s_cselect_b32 s38, 1.0, 0x3ea52b5c
    s_cselect_b32 s39, 5, 0
    s_sub_u32 s39, s25, s39
    s_lshl_b32 s39, s39, 5
    s_lshl_b32 s30, s28, 4
    s_add_u32 s39, s39, s30
    s_mul_i32 s36, s36, s34
    s_add_u32 s37, s37, s36
    v_lshl_add_u32 v55, v48, 4, s37
    s_xor_b32 s32, s28, 1
    s_lshr_b32 s39, s39, 1
    s_sub_u32 s40, s35, 1024
    s_cmp_eq_u32 s28, 0
    s_cselect_b64 s[42:43], -1, 0
    s_xor_b32 s30, s27, 0
    s_lshl_b32 s30, s30, 2
    s_add_u32 s30, s30, s39
    v_add_u32 v56, s30, v49
    v_mul_u32_u24 v50, 205, v56
    v_lshrrev_b32 v50, 10, v50
    v_mul_u32_u24 v51, 5, v50
    v_sub_u32 v51, v56, v51
    v_add_u32 v52, 1, v51
    v_lshrrev_b32 v52, 2, v52
    v_lshl_add_u32 v50, v50, 1, v52
    v_mul_u32_u24 v52, 3, v52
    v_sub_u32 v51, v51, v52
    v_mad_u32_u24 v50, v50, s35, v55
    v_lshl_add_u32 v50, v51, 9, v50
    v_cmp_eq_u32 s[50:51], 2, v51
    v_lshrrev_b32 v52, 1, v51
    v_lshl_add_u32 v50, v52, 10, v50
    v_mul_u32_u24 v52, s40, v52
    v_add_u32 v52, 1024, v52
    v_mad_u32_u24 v128, v52, s28, v50
    v_mad_u32_u24 v132, v52, s32, v50
    s_andn2_b64 s[52:53], s[50:51], s[42:43]
    s_and_b64 s[50:51], s[50:51], s[42:43]
    v_add_u32 v56, 2, v56
    v_mul_u32_u24 v50, 205, v56
    v_lshrrev_b32 v50, 10, v50
    v_mul_u32_u24 v51, 5, v50
    v_sub_u32 v51, v56, v51
    v_add_u32 v52, 1, v51
    v_lshrrev_b32 v52, 2, v52
    v_lshl_add_u32 v50, v50, 1, v52
    v_mul_u32_u24 v52, 3, v52
    v_sub_u32 v51, v51, v52
    v_mad_u32_u24 v50, v50, s35, v55
    v_lshl_add_u32 v50, v51, 9, v50
    v_cmp_eq_u32 s[54:55], 2, v51
    v_lshrrev_b32 v52, 1, v51
    v_lshl_add_u32 v50, v52, 10, v50
    v_mul_u32_u24 v52, s40, v52
    v_add_u32 v52, 1024, v52
    v_mad_u32_u24 v129, v52, s28, v50
    v_mad_u32_u24 v133, v52, s32, v50
    s_andn2_b64 s[56:57], s[54:55], s[42:43]
    s_and_b64 s[54:55], s[54:55], s[42:43]
    s_xor_b32 s30, s27, 1
    s_lshl_b32 s30, s30, 2
    s_add_u32 s30, s30, s39
    v_add_u32 v56, s30, v49
    v_mul_u32_u24 v50, 205, v56
    v_lshrrev_b32 v50, 10, v50
    v_mul_u32_u24 v51, 5, v50
    v_sub_u32 v51, v56, v51
    v_add_u32 v52, 1, v51
    v_lshrrev_b32 v52, 2, v52
    v_lshl_add_u32 v50, v50, 1, v52
    v_mul_u32_u24 v52, 3, v52
    v_sub_u32 v51, v51, v52
    v_mad_u32_u24 v50, v50, s35, v55
    v_lshl_add_u32 v50, v51, 9, v50
    v_cmp_eq_u32 s[58:59], 2, v51
    v_lshrrev_b32 v52, 1, v51
    v_lshl_add_u32 v50, v52, 10, v50
    v_mul_u32_u24 v52, s40, v52
    v_add_u32 v52, 1024, v52
    v_mad_u32_u24 v130, v52, s28, v50
    v_mad_u32_u24 v134, v52, s32, v50
    s_andn2_b64 s[60:61], s[58:59], s[42:43]
    s_and_b64 s[58:59], s[58:59], s[42:43]
    v_add_u32 v56, 2, v56
    v_mul_u32_u24 v50, 205, v56
    v_lshrrev_b32 v50, 10, v50
    v_mul_u32_u24 v51, 5, v50
    v_sub_u32 v51, v56, v51
    v_add_u32 v52, 1, v51
    v_lshrrev_b32 v52, 2, v52
    v_lshl_add_u32 v50, v50, 1, v52
    v_mul_u32_u24 v52, 3, v52
    v_sub_u32 v51, v51, v52
    v_mad_u32_u24 v50, v50, s35, v55
    v_lshl_add_u32 v50, v51, 9, v50
    v_cmp_eq_u32 s[62:63], 2, v51
    v_lshrrev_b32 v52, 1, v51
    v_lshl_add_u32 v50, v52, 10, v50
    v_mul_u32_u24 v52, s40, v52
    v_add_u32 v52, 1024, v52
    v_mad_u32_u24 v131, v52, s28, v50
    v_mad_u32_u24 v135, v52, s32, v50
    s_andn2_b64 s[64:65], s[62:63], s[42:43]
    s_and_b64 s[62:63], s[62:63], s[42:43]
    s_lshl_b32 s30, s27, 8
    s_lshl_b32 s31, s28, 7
    s_add_u32 s30, s30, s31
    s_add_u32 s30, s30, 131072
    s_lshl_b32 s31, s28, 8
    s_lshl_b32 s29, s27, 7
    s_add_u32 s31, s31, s29
    s_add_u32 s31, s31, 132096
    v_lshl_add_u32 v55, v48, 2, s30
    v_lshl_add_u32 v56, v48, 2, s31
    v_xor_b32 v57, 128, v55
    v_lshl_add_u32 v56, v49, 4, s31
    v_xor_b32 v54, 128, v56
    s_barrier
    ds_read_b128 v[16:19], v2 offset:0
    ds_read_b64_tr_b16 v[24:25], v10 offset:0
    ds_read_b64_tr_b16 v[26:27], v10 offset:1024
    ds_read_b128 v[20:23], v6 offset:0
    ds_read_b64_tr_b16 v[28:29], v11 offset:0
    ds_read_b64_tr_b16 v[30:31], v11 offset:1024
.p2align 4
K1_LOOPQ:
    s_waitcnt lgkmcnt(0)
    v_mfma_f32_32x32x16_bf16 v[64:79], v[24:27], v[16:19], v[64:79]
    ds_read_b128 v[32:35], v3 offset:0
    ds_read_b64_tr_b16 v[40:41], v10 offset:4096
    ds_read_b64_tr_b16 v[42:43], v10 offset:5120
    v_mfma_f32_32x32x16_bf16 v[80:95], v[28:31], v[16:19], v[80:95]
    ds_read_b128 v[36:39], v7 offset:0
    ds_read_b64_tr_b16 v[44:45], v11 offset:4096
    ds_read_b64_tr_b16 v[46:47], v11 offset:5120
    v_mfma_f32_32x32x16_bf16 v[96:111], v[24:27], v[20:23], v[96:111]
    v_mfma_f32_32x32x16_bf16 v[112:127], v[28:31], v[20:23], v[112:127]
    s_waitcnt lgkmcnt(0)
    v_mfma_f32_32x32x16_bf16 v[64:79], v[40:43], v[32:35], v[64:79]
    ds_read_b128 v[16:19], v4 offset:0
    ds_read_b64_tr_b16 v[24:25], v10 offset:8192
    ds_read_b64_tr_b16 v[26:27], v10 offset:9216
    v_mfma_f32_32x32x16_bf16 v[80:95], v[44:47], v[32:35], v[80:95]
    ds_read_b128 v[20:23], v8 offset:0
    ds_read_b64_tr_b16 v[28:29], v11 offset:8192
    ds_read_b64_tr_b16 v[30:31], v11 offset:9216
    v_mfma_f32_32x32x16_bf16 v[96:111], v[40:43], v[36:39], v[96:111]
    v_mfma_f32_32x32x16_bf16 v[112:127], v[44:47], v[36:39], v[112:127]
    s_waitcnt lgkmcnt(0)
    v_mfma_f32_32x32x16_bf16 v[64:79], v[24:27], v[16:19], v[64:79]
    ds_read_b128 v[32:35], v5 offset:0
    ds_read_b64_tr_b16 v[40:41], v10 offset:12288
    ds_read_b64_tr_b16 v[42:43], v10 offset:13312
    v_mfma_f32_32x32x16_bf16 v[80:95], v[28:31], v[16:19], v[80:95]
    ds_read_b128 v[36:39], v9 offset:0
    ds_read_b64_tr_b16 v[44:45], v11 offset:12288
    ds_read_b64_tr_b16 v[46:47], v11 offset:13312
    v_mfma_f32_32x32x16_bf16 v[96:111], v[24:27], v[20:23], v[96:111]
    v_mfma_f32_32x32x16_bf16 v[112:127], v[28:31], v[20:23], v[112:127]
    s_waitcnt lgkmcnt(0)
    v_mfma_f32_32x32x16_bf16 v[64:79], v[40:43], v[32:35], v[64:79]
    v_mfma_f32_32x32x16_bf16 v[80:95], v[44:47], v[32:35], v[80:95]
    s_barrier
    ds_read_b128 v[16:19], v2 offset:32768
    ds_read_b64_tr_b16 v[24:25], v10 offset:32768
    ds_read_b64_tr_b16 v[26:27], v10 offset:33792
    ds_read_b128 v[20:23], v6 offset:32768
    ds_read_b64_tr_b16 v[28:29], v11 offset:32768
    ds_read_b64_tr_b16 v[30:31], v11 offset:33792
    v_mfma_f32_32x32x16_bf16 v[96:111], v[40:43], v[36:39], v[96:111]
    v_mfma_f32_32x32x16_bf16 v[112:127], v[44:47], v[36:39], v[112:127]
    s_waitcnt lgkmcnt(0)
    v_mfma_f32_32x32x16_bf16 v[64:79], v[24:27], v[16:19], v[64:79]
    ds_read_b128 v[32:35], v3 offset:32768
    ds_read_b64_tr_b16 v[40:41], v10 offset:36864
    ds_read_b64_tr_b16 v[42:43], v10 offset:37888
    v_mfma_f32_32x32x16_bf16 v[80:95], v[28:31], v[16:19], v[80:95]
    ds_read_b128 v[36:39], v7 offset:32768
    ds_read_b64_tr_b16 v[44:45], v11 offset:36864
    ds_read_b64_tr_b16 v[46:47], v11 offset:37888
    v_mfma_f32_32x32x16_bf16 v[96:111], v[24:27], v[20:23], v[96:111]
    v_mfma_f32_32x32x16_bf16 v[112:127], v[28:31], v[20:23], v[112:127]
    s_waitcnt lgkmcnt(0)
    v_mfma_f32_32x32x16_bf16 v[64:79], v[40:43], v[32:35], v[64:79]
    ds_read_b128 v[16:19], v4 offset:32768
    ds_read_b64_tr_b16 v[24:25], v10 offset:40960
    ds_read_b64_tr_b16 v[26:27], v10 offset:41984
    v_mfma_f32_32x32x16_bf16 v[80:95], v[44:47], v[32:35], v[80:95]
    ds_read_b128 v[20:23], v8 offset:32768
    ds_read_b64_tr_b16 v[28:29], v11 offset:40960
    ds_read_b64_tr_b16 v[30:31], v11 offset:41984
    v_mfma_f32_32x32x16_bf16 v[96:111], v[40:43], v[36:39], v[96:111]
    v_mfma_f32_32x32x16_bf16 v[112:127], v[44:47], v[36:39], v[112:127]
    s_waitcnt lgkmcnt(0)
    v_mfma_f32_32x32x16_bf16 v[64:79], v[24:27], v[16:19], v[64:79]
    ds_read_b128 v[32:35], v5 offset:32768
    ds_read_b64_tr_b16 v[40:41], v10 offset:45056
    ds_read_b64_tr_b16 v[42:43], v10 offset:46080
    v_mfma_f32_32x32x16_bf16 v[80:95], v[28:31], v[16:19], v[80:95]
    ds_read_b128 v[36:39], v9 offset:32768
    ds_read_b64_tr_b16 v[44:45], v11 offset:45056
    ds_read_b64_tr_b16 v[46:47], v11 offset:46080
    v_mfma_f32_32x32x16_bf16 v[96:111], v[24:27], v[20:23], v[96:111]
    v_mfma_f32_32x32x16_bf16 v[112:127], v[28:31], v[20:23], v[112:127]
    s_waitcnt lgkmcnt(0)
    v_mfma_f32_32x32x16_bf16 v[64:79], v[40:43], v[32:35], v[64:79]
    v_xor_b32 v2, 0x10000, v2
    v_xor_b32 v3, 0x10000, v3
    v_xor_b32 v4, 0x10000, v4
    v_xor_b32 v5, 0x10000, v5
    v_xor_b32 v6, 0x10000, v6
    v_xor_b32 v7, 0x10000, v7
    v_xor_b32 v8, 0x10000, v8
    v_xor_b32 v9, 0x10000, v9
    v_xor_b32 v10, 0x10000, v10
    v_xor_b32 v11, 0x10000, v11
    v_mfma_f32_32x32x16_bf16 v[80:95], v[44:47], v[32:35], v[80:95]
    s_barrier
    ds_read_b128 v[16:19], v2 offset:0
    ds_read_b64_tr_b16 v[24:25], v10 offset:0
    ds_read_b64_tr_b16 v[26:27], v10 offset:1024
    ds_read_b128 v[20:23], v6 offset:0
    ds_read_b64_tr_b16 v[28:29], v11 offset:0
    ds_read_b64_tr_b16 v[30:31], v11 offset:1024
    v_mfma_f32_32x32x16_bf16 v[96:111], v[40:43], v[36:39], v[96:111]
    v_mfma_f32_32x32x16_bf16 v[112:127], v[44:47], v[36:39], v[112:127]
    s_sub_u32 s33, s33, 1
    s_cmp_lg_u32 s33, 0
    s_cbranch_scc1 K1_LOOPQ
    s_waitcnt lgkmcnt(0)
    ds_read2_b32 v[52:53], v55 offset0:0 offset1:128
    ds_read2_b32 v[58:59], v57 offset0:0 offset1:128
    ds_read_b32 v60, v191 offset:12
    ds_read_b128 v[16:19], v56 offset:0
    ds_read_b128 v[20:23], v56 offset:32
    ds_read_b128 v[24:27], v56 offset:64
    ds_read_b128 v[28:31], v56 offset:96
    ds_read_b128 v[32:35], v54 offset:0
    ds_read_b128 v[36:39], v54 offset:32
    ds_read_b128 v[40:43], v54 offset:64
    ds_read_b128 v[44:47], v54 offset:96
    s_waitcnt lgkmcnt(4)
    v_pk_fma_f32 v[64:65], v[16:17], v[52:53], v[64:65] op_sel:[0,1,0] op_sel_hi:[1,1,1]
    v_pk_fma_f32 v[66:67], v[18:19], v[52:53], v[66:67] op_sel:[0,1,0] op_sel_hi:[1,1,1]
    v_pk_fma_f32 v[68:69], v[20:21], v[52:53], v[68:69] op_sel:[0,1,0] op_sel_hi:[1,1,1]
    v_pk_fma_f32 v[70:71], v[22:23], v[52:53], v[70:71] op_sel:[0,1,0] op_sel_hi:[1,1,1]
    v_pk_mul_f32 v[64:65], v[64:65], v[52:53] op_sel:[0,0] op_sel_hi:[1,0]
    v_pk_mul_f32 v[66:67], v[66:67], v[52:53] op_sel:[0,0] op_sel_hi:[1,0]
    v_pk_mul_f32 v[68:69], v[68:69], v[52:53] op_sel:[0,0] op_sel_hi:[1,0]
    v_pk_mul_f32 v[70:71], v[70:71], v[52:53] op_sel:[0,0] op_sel_hi:[1,0]
    v_cvt_pk_bf16_f32 v64, v64, v65
    v_cvt_pk_bf16_f32 v65, v66, v67
    v_cvt_pk_bf16_f32 v66, v68, v69
    v_cvt_pk_bf16_f32 v67, v70, v71
    v_pk_fma_f32 v[96:97], v[16:17], v[58:59], v[96:97] op_sel:[0,1,0] op_sel_hi:[1,1,1]
    v_pk_fma_f32 v[98:99], v[18:19], v[58:59], v[98:99] op_sel:[0,1,0] op_sel_hi:[1,1,1]
    v_pk_fma_f32 v[100:101], v[20:21], v[58:59], v[100:101] op_sel:[0,1,0] op_sel_hi:[1,1,1]
    v_pk_fma_f32 v[102:103], v[22:23], v[58:59], v[102:103] op_sel:[0,1,0] op_sel_hi:[1,1,1]
    v_pk_mul_f32 v[96:97], v[96:97], v[58:59] op_sel:[0,0] op_sel_hi:[1,0]
    v_pk_mul_f32 v[98:99], v[98:99], v[58:59] op_sel:[0,0] op_sel_hi:[1,0]
    v_pk_mul_f32 v[100:101], v[100:101], v[58:59] op_sel:[0,0] op_sel_hi:[1,0]
    v_pk_mul_f32 v[102:103], v[102:103], v[58:59] op_sel:[0,0] op_sel_hi:[1,0]
    v_cvt_pk_bf16_f32 v96, v96, v97
    v_cvt_pk_bf16_f32 v97, v98, v99
    v_cvt_pk_bf16_f32 v98, v100, v101
    v_cvt_pk_bf16_f32 v99, v102, v103
    v_permlane32_swap_b32 v64, v66
    v_permlane32_swap_b32 v65, v67
    v_permlane32_swap_b32 v96, v98
    v_permlane32_swap_b32 v97, v99
    s_mov_b64 exec, s[50:51]
    v_swap_b32 v66, v96
    v_swap_b32 v67, v97
    s_mov_b64 exec, s[52:53]
    v_swap_b32 v64, v98
    v_swap_b32 v65, v99
    s_mov_b64 exec, -1
    buffer_store_dwordx4 v[64:67], v128, s[20:23], 0 offen sc1
    buffer_store_dwordx4 v[96:99], v132, s[20:23], 0 offen sc1
    v_pk_fma_f32 v[72:73], v[24:25], v[52:53], v[72:73] op_sel:[0,1,0] op_sel_hi:[1,1,1]
    v_pk_fma_f32 v[74:75], v[26:27], v[52:53], v[74:75] op_sel:[0,1,0] op_sel_hi:[1,1,1]
    v_pk_fma_f32 v[76:77], v[28:29], v[52:53], v[76:77] op_sel:[0,1,0] op_sel_hi:[1,1,1]
    v_pk_fma_f32 v[78:79], v[30:31], v[52:53], v[78:79] op_sel:[0,1,0] op_sel_hi:[1,1,1]
    v_pk_mul_f32 v[72:73], v[72:73], v[52:53] op_sel:[0,0] op_sel_hi:[1,0]
    v_pk_mul_f32 v[74:75], v[74:75], v[52:53] op_sel:[0,0] op_sel_hi:[1,0]
    v_pk_mul_f32 v[76:77], v[76:77], v[52:53] op_sel:[0,0] op_sel_hi:[1,0]
    v_pk_mul_f32 v[78:79], v[78:79], v[52:53] op_sel:[0,0] op_sel_hi:[1,0]
    v_cvt_pk_bf16_f32 v72, v72, v73
    v_cvt_pk_bf16_f32 v73, v74, v75
    v_cvt_pk_bf16_f32 v74, v76, v77
    v_cvt_pk_bf16_f32 v75, v78, v79
    v_pk_fma_f32 v[104:105], v[24:25], v[58:59], v[104:105] op_sel:[0,1,0] op_sel_hi:[1,1,1]
    v_pk_fma_f32 v[106:107], v[26:27], v[58:59], v[106:107] op_sel:[0,1,0] op_sel_hi:[1,1,1]
    v_pk_fma_f32 v[108:109], v[28:29], v[58:59], v[108:109] op_sel:[0,1,0] op_sel_hi:[1,1,1]
    v_pk_fma_f32 v[110:111], v[30:31], v[58:59], v[110:111] op_sel:[0,1,0] op_sel_hi:[1,1,1]
    v_pk_mul_f32 v[104:105], v[104:105], v[58:59] op_sel:[0,0] op_sel_hi:[1,0]
    v_pk_mul_f32 v[106:107], v[106:107], v[58:59] op_sel:[0,0] op_sel_hi:[1,0]
    v_pk_mul_f32 v[108:109], v[108:109], v[58:59] op_sel:[0,0] op_sel_hi:[1,0]
    v_pk_mul_f32 v[110:111], v[110:111], v[58:59] op_sel:[0,0] op_sel_hi:[1,0]
    v_cvt_pk_bf16_f32 v104, v104, v105
    v_cvt_pk_bf16_f32 v105, v106, v107
    v_cvt_pk_bf16_f32 v106, v108, v109
    v_cvt_pk_bf16_f32 v107, v110, v111
    v_permlane32_swap_b32 v72, v74
    v_permlane32_swap_b32 v73, v75
    v_permlane32_swap_b32 v104, v106
    v_permlane32_swap_b32 v105, v107
    s_mov_b64 exec, s[54:55]
    v_swap_b32 v74, v104
    v_swap_b32 v75, v105
    s_mov_b64 exec, s[56:57]
    v_swap_b32 v72, v106
    v_swap_b32 v73, v107
    s_mov_b64 exec, -1
    buffer_store_dwordx4 v[72:75], v129, s[20:23], 0 offen sc1
    buffer_store_dwordx4 v[104:107], v133, s[20:23], 0 offen sc1
    s_waitcnt lgkmcnt(0)
    v_pk_fma_f32 v[80:81], v[32:33], v[52:53], v[80:81] op_sel:[0,1,0] op_sel_hi:[1,1,1]
    v_pk_fma_f32 v[82:83], v[34:35], v[52:53], v[82:83] op_sel:[0,1,0] op_sel_hi:[1,1,1]
    v_pk_fma_f32 v[84:85], v[36:37], v[52:53], v[84:85] op_sel:[0,1,0] op_sel_hi:[1,1,1]
    v_pk_fma_f32 v[86:87], v[38:39], v[52:53], v[86:87] op_sel:[0,1,0] op_sel_hi:[1,1,1]
    v_pk_mul_f32 v[80:81], v[80:81], v[52:53] op_sel:[0,0] op_sel_hi:[1,0]
    v_pk_mul_f32 v[82:83], v[82:83], v[52:53] op_sel:[0,0] op_sel_hi:[1,0]
    v_pk_mul_f32 v[84:85], v[84:85], v[52:53] op_sel:[0,0] op_sel_hi:[1,0]
    v_pk_mul_f32 v[86:87], v[86:87], v[52:53] op_sel:[0,0] op_sel_hi:[1,0]
    v_cvt_pk_bf16_f32 v80, v80, v81
    v_cvt_pk_bf16_f32 v81, v82, v83
    v_cvt_pk_bf16_f32 v82, v84, v85
    v_cvt_pk_bf16_f32 v83, v86, v87
    v_pk_fma_f32 v[112:113], v[32:33], v[58:59], v[112:113] op_sel:[0,1,0] op_sel_hi:[1,1,1]
    v_pk_fma_f32 v[114:115], v[34:35], v[58:59], v[114:115] op_sel:[0,1,0] op_sel_hi:[1,1,1]
    v_pk_fma_f32 v[116:117], v[36:37], v[58:59], v[116:117] op_sel:[0,1,0] op_sel_hi:[1,1,1]
    v_pk_fma_f32 v[118:119], v[38:39], v[58:59], v[118:119] op_sel:[0,1,0] op_sel_hi:[1,1,1]
    v_pk_mul_f32 v[112:113], v[112:113], v[58:59] op_sel:[0,0] op_sel_hi:[1,0]
    v_pk_mul_f32 v[114:115], v[114:115], v[58:59] op_sel:[0,0] op_sel_hi:[1,0]
    v_pk_mul_f32 v[116:117], v[116:117], v[58:59] op_sel:[0,0] op_sel_hi:[1,0]
    v_pk_mul_f32 v[118:119], v[118:119], v[58:59] op_sel:[0,0] op_sel_hi:[1,0]
    v_cvt_pk_bf16_f32 v112, v112, v113
    v_cvt_pk_bf16_f32 v113, v114, v115
    v_cvt_pk_bf16_f32 v114, v116, v117
    v_cvt_pk_bf16_f32 v115, v118, v119
    v_permlane32_swap_b32 v80, v82
    v_permlane32_swap_b32 v81, v83
    v_permlane32_swap_b32 v112, v114
    v_permlane32_swap_b32 v113, v115
    s_mov_b64 exec, s[58:59]
    v_swap_b32 v82, v112
    v_swap_b32 v83, v113
    s_mov_b64 exec, s[60:61]
    v_swap_b32 v80, v114
    v_swap_b32 v81, v115
    s_mov_b64 exec, -1
    buffer_store_dwordx4 v[80:83], v130, s[20:23], 0 offen sc1
    buffer_store_dwordx4 v[112:115], v134, s[20:23], 0 offen sc1
    v_pk_fma_f32 v[88:89], v[40:41], v[52:53], v[88:89] op_sel:[0,1,0] op_sel_hi:[1,1,1]
    v_pk_fma_f32 v[90:91], v[42:43], v[52:53], v[90:91] op_sel:[0,1,0] op_sel_hi:[1,1,1]
    v_pk_fma_f32 v[92:93], v[44:45], v[52:53], v[92:93] op_sel:[0,1,0] op_sel_hi:[1,1,1]
    v_pk_fma_f32 v[94:95], v[46:47], v[52:53], v[94:95] op_sel:[0,1,0] op_sel_hi:[1,1,1]
    v_pk_mul_f32 v[88:89], v[88:89], v[52:53] op_sel:[0,0] op_sel_hi:[1,0]
    v_pk_mul_f32 v[90:91], v[90:91], v[52:53] op_sel:[0,0] op_sel_hi:[1,0]
    v_pk_mul_f32 v[92:93], v[92:93], v[52:53] op_sel:[0,0] op_sel_hi:[1,0]
    v_pk_mul_f32 v[94:95], v[94:95], v[52:53] op_sel:[0,0] op_sel_hi:[1,0]
    v_cvt_pk_bf16_f32 v88, v88, v89
    v_cvt_pk_bf16_f32 v89, v90, v91
    v_cvt_pk_bf16_f32 v90, v92, v93
    v_cvt_pk_bf16_f32 v91, v94, v95
    v_pk_fma_f32 v[120:121], v[40:41], v[58:59], v[120:121] op_sel:[0,1,0] op_sel_hi:[1,1,1]
    v_pk_fma_f32 v[122:123], v[42:43], v[58:59], v[122:123] op_sel:[0,1,0] op_sel_hi:[1,1,1]
    v_pk_fma_f32 v[124:125], v[44:45], v[58:59], v[124:125] op_sel:[0,1,0] op_sel_hi:[1,1,1]
    v_pk_fma_f32 v[126:127], v[46:47], v[58:59], v[126:127] op_sel:[0,1,0] op_sel_hi:[1,1,1]
    v_pk_mul_f32 v[120:121], v[120:121], v[58:59] op_sel:[0,0] op_sel_hi:[1,0]
    v_pk_mul_f32 v[122:123], v[122:123], v[58:59] op_sel:[0,0] op_sel_hi:[1,0]
    v_pk_mul_f32 v[124:125], v[124:125], v[58:59] op_sel:[0,0] op_sel_hi:[1,0]
    v_pk_mul_f32 v[126:127], v[126:127], v[58:59] op_sel:[0,0] op_sel_hi:[1,0]
    v_cvt_pk_bf16_f32 v120, v120, v121
    v_cvt_pk_bf16_f32 v121, v122, v123
    v_cvt_pk_bf16_f32 v122, v124, v125
    v_cvt_pk_bf16_f32 v123, v126, v127
    v_permlane32_swap_b32 v88, v90
    v_permlane32_swap_b32 v89, v91
    v_permlane32_swap_b32 v120, v122
    v_permlane32_swap_b32 v121, v123
    s_mov_b64 exec, s[62:63]
    v_swap_b32 v90, v120
    v_swap_b32 v91, v121
    s_mov_b64 exec, s[64:65]
    v_swap_b32 v88, v122
    v_swap_b32 v89, v123
    s_mov_b64 exec, -1
    buffer_store_dwordx4 v[88:91], v131, s[20:23], 0 offen sc1
    buffer_store_dwordx4 v[120:123], v135, s[20:23], 0 offen sc1
    s_branch K2_CT
K1_V:
    s_sub_u32 s39, s25, 10
    s_lshl_b32 s39, s39, 7
    s_lshl_b32 s30, s28, 6
    s_add_u32 s39, s39, s30
    s_mul_i32 s36, s34, 82048
    s_add_u32 s37, s36, 5242880
    v_mul_u32_u24 v55, 10240, v49
    v_add_u32 v55, s37, v55
    s_mul_i32 s40, s28, 40960
    s_add_u32 s41, s40, 20480
    s_sub_u32 s42, 40960, s40
    s_add_u32 s43, s42, 20480
    s_xor_b32 s30, s27, 0
    s_lshl_b32 s30, s30, 5
    s_add_u32 s30, s30, s39
    v_add_u32 v56, s30, v48
    v_lshl_add_u32 v128, v56, 4, v55
    s_xor_b32 s30, s27, 1
    s_lshl_b32 s30, s30, 5
    s_add_u32 s30, s30, s39
    v_add_u32 v56, s30, v48
    v_lshl_add_u32 v129, v56, 4, v55
    s_lshl_b32 s30, s27, 8
    s_lshl_b32 s31, s28, 7
    s_add_u32 s30, s30, s31
    s_add_u32 s30, s30, 131072
    s_lshl_b32 s31, s28, 8
    s_lshl_b32 s29, s27, 7
    s_add_u32 s31, s31, s29
    s_add_u32 s31, s31, 132096
    v_lshl_add_u32 v55, v48, 2, s30
    v_lshl_add_u32 v56, v48, 2, s31
    v_xor_b32 v57, 128, v56
    v_lshl_add_u32 v55, v49, 4, s30
    v_xor_b32 v53, 128, v55
    s_barrier
    ds_read_b128 v[16:19], v2 offset:0
    ds_read_b64_tr_b16 v[24:25], v10 offset:0
    ds_read_b64_tr_b16 v[26:27], v10 offset:1024
    ds_read_b128 v[20:23], v6 offset:0
    ds_read_b64_tr_b16 v[28:29], v11 offset:0
    ds_read_b64_tr_b16 v[30:31], v11 offset:1024
.p2align 4
K1_LOOPV:
    s_waitcnt lgkmcnt(0)
    v_mfma_f32_32x32x16_bf16 v[64:79], v[16:19], v[24:27], v[64:79]
    ds_read_b128 v[32:35], v3 offset:0
    ds_read_b64_tr_b16 v[40:41], v10 offset:4096
    ds_read_b64_tr_b16 v[42:43], v10 offset:5120
    v_mfma_f32_32x32x16_bf16 v[80:95], v[16:19], v[28:31], v[80:95]
    ds_read_b128 v[36:39], v7 offset:0
    ds_read_b64_tr_b16 v[44:45], v11 offset:4096
    ds_read_b64_tr_b16 v[46:47], v11 offset:5120
    v_mfma_f32_32x32x16_bf16 v[96:111], v[20:23], v[24:27], v[96:111]
    v_mfma_f32_32x32x16_bf16 v[112:127], v[20:23], v[28:31], v[112:127]
    s_waitcnt lgkmcnt(0)
    v_mfma_f32_32x32x16_bf16 v[64:79], v[32:35], v[40:43], v[64:79]
    ds_read_b128 v[16:19], v4 offset:0
    ds_read_b64_tr_b16 v[24:25], v10 offset:8192
    ds_read_b64_tr_b16 v[26:27], v10 offset:9216
    v_mfma_f32_32x32x16_bf16 v[80:95], v[32:35], v[44:47], v[80:95]
    ds_read_b128 v[20:23], v8 offset:0
    ds_read_b64_tr_b16 v[28:29], v11 offset:8192
    ds_read_b64_tr_b16 v[30:31], v11 offset:9216
    v_mfma_f32_32x32x16_bf16 v[96:111], v[36:39], v[40:43], v[96:111]
    v_mfma_f32_32x32x16_bf16 v[112:127], v[36:39], v[44:47], v[112:127]
    s_waitcnt lgkmcnt(0)
    v_mfma_f32_32x32x16_bf16 v[64:79], v[16:19], v[24:27], v[64:79]
    ds_read_b128 v[32:35], v5 offset:0
    ds_read_b64_tr_b16 v[40:41], v10 offset:12288
    ds_read_b64_tr_b16 v[42:43], v10 offset:13312
    v_mfma_f32_32x32x16_bf16 v[80:95], v[16:19], v[28:31], v[80:95]
    ds_read_b128 v[36:39], v9 offset:0
    ds_read_b64_tr_b16 v[44:45], v11 offset:12288
    ds_read_b64_tr_b16 v[46:47], v11 offset:13312
    v_mfma_f32_32x32x16_bf16 v[96:111], v[20:23], v[24:27], v[96:111]
    v_mfma_f32_32x32x16_bf16 v[112:127], v[20:23], v[28:31], v[112:127]
    s_waitcnt lgkmcnt(0)
    v_mfma_f32_32x32x16_bf16 v[64:79], v[32:35], v[40:43], v[64:79]
    v_mfma_f32_32x32x16_bf16 v[80:95], v[32:35], v[44:47], v[80:95]
    s_barrier
    ds_read_b128 v[16:19], v2 offset:32768
    ds_read_b64_tr_b16 v[24:25], v10 offset:32768
    ds_read_b64_tr_b16 v[26:27], v10 offset:33792
    ds_read_b128 v[20:23], v6 offset:32768
    ds_read_b64_tr_b16 v[28:29], v11 offset:32768
    ds_read_b64_tr_b16 v[30:31], v11 offset:33792
    v_mfma_f32_32x32x16_bf16 v[96:111], v[36:39], v[40:43], v[96:111]
    v_mfma_f32_32x32x16_bf16 v[112:127], v[36:39], v[44:47], v[112:127]
    s_waitcnt lgkmcnt(0)
    v_mfma_f32_32x32x16_bf16 v[64:79], v[16:19], v[24:27], v[64:79]
    ds_read_b128 v[32:35], v3 offset:32768
    ds_read_b64_tr_b16 v[40:41], v10 offset:36864
    ds_read_b64_tr_b16 v[42:43], v10 offset:37888
    v_mfma_f32_32x32x16_bf16 v[80:95], v[16:19], v[28:31], v[80:95]
    ds_read_b128 v[36:39], v7 offset:32768
    ds_read_b64_tr_b16 v[44:45], v11 offset:36864
    ds_read_b64_tr_b16 v[46:47], v11 offset:37888
    v_mfma_f32_32x32x16_bf16 v[96:111], v[20:23], v[24:27], v[96:111]
    v_mfma_f32_32x32x16_bf16 v[112:127], v[20:23], v[28:31], v[112:127]
    s_waitcnt lgkmcnt(0)
    v_mfma_f32_32x32x16_bf16 v[64:79], v[32:35], v[40:43], v[64:79]
    ds_read_b128 v[16:19], v4 offset:32768
    ds_read_b64_tr_b16 v[24:25], v10 offset:40960
    ds_read_b64_tr_b16 v[26:27], v10 offset:41984
    v_mfma_f32_32x32x16_bf16 v[80:95], v[32:35], v[44:47], v[80:95]
    ds_read_b128 v[20:23], v8 offset:32768
    ds_read_b64_tr_b16 v[28:29], v11 offset:40960
    ds_read_b64_tr_b16 v[30:31], v11 offset:41984
    v_mfma_f32_32x32x16_bf16 v[96:111], v[36:39], v[40:43], v[96:111]
    v_mfma_f32_32x32x16_bf16 v[112:127], v[36:39], v[44:47], v[112:127]
    s_waitcnt lgkmcnt(0)
    v_mfma_f32_32x32x16_bf16 v[64:79], v[16:19], v[24:27], v[64:79]
    ds_read_b128 v[32:35], v5 offset:32768
    ds_read_b64_tr_b16 v[40:41], v10 offset:45056
    ds_read_b64_tr_b16 v[42:43], v10 offset:46080
    v_mfma_f32_32x32x16_bf16 v[80:95], v[16:19], v[28:31], v[80:95]
    ds_read_b128 v[36:39], v9 offset:32768
    ds_read_b64_tr_b16 v[44:45], v11 offset:45056
    ds_read_b64_tr_b16 v[46:47], v11 offset:46080
    v_mfma_f32_32x32x16_bf16 v[96:111], v[20:23], v[24:27], v[96:111]
    v_mfma_f32_32x32x16_bf16 v[112:127], v[20:23], v[28:31], v[112:127]
    s_waitcnt lgkmcnt(0)
    v_mfma_f32_32x32x16_bf16 v[64:79], v[32:35], v[40:43], v[64:79]
    v_xor_b32 v2, 0x10000, v2
    v_xor_b32 v3, 0x10000, v3
    v_xor_b32 v4, 0x10000, v4
    v_xor_b32 v5, 0x10000, v5
    v_xor_b32 v6, 0x10000, v6
    v_xor_b32 v7, 0x10000, v7
    v_xor_b32 v8, 0x10000, v8
    v_xor_b32 v9, 0x10000, v9
    v_xor_b32 v10, 0x10000, v10
    v_xor_b32 v11, 0x10000, v11
    v_mfma_f32_32x32x16_bf16 v[80:95], v[32:35], v[44:47], v[80:95]
    s_barrier
    ds_read_b128 v[16:19], v2 offset:0
    ds_read_b64_tr_b16 v[24:25], v10 offset:0
    ds_read_b64_tr_b16 v[26:27], v10 offset:1024
    ds_read_b128 v[20:23], v6 offset:0
    ds_read_b64_tr_b16 v[28:29], v11 offset:0
    ds_read_b64_tr_b16 v[30:31], v11 offset:1024
    v_mfma_f32_32x32x16_bf16 v[96:111], v[36:39], v[40:43], v[96:111]
    v_mfma_f32_32x32x16_bf16 v[112:127], v[36:39], v[44:47], v[112:127]
    s_sub_u32 s33, s33, 1
    s_cmp_lg_u32 s33, 0
    s_cbranch_scc1 K1_LOOPV
    s_waitcnt lgkmcnt(0)
    ds_read_b32 v54, v56
    ds_read_b32 v58, v57
    ds_read_b32 v60, v191 offset:12
    ds_read_b128 v[16:19], v55 offset:0
    ds_read_b128 v[32:35], v55 offset:512
    ds_read_b128 v[20:23], v55 offset:32
    ds_read_b128 v[36:39], v55 offset:544
    ds_read_b128 v[24:27], v55 offset:64
    ds_read_b128 v[40:43], v55 offset:576
    ds_read_b128 v[28:31], v55 offset:96
    ds_read_b128 v[44:47], v55 offset:608
    ds_read_b128 v[144:147], v53 offset:0
    ds_read_b128 v[160:163], v53 offset:512
    ds_read_b128 v[148:151], v53 offset:32
    ds_read_b128 v[164:167], v53 offset:544
    ds_read_b128 v[152:155], v53 offset:64
    ds_read_b128 v[168:171], v53 offset:576
    ds_read_b128 v[156:159], v53 offset:96
    ds_read_b128 v[172:175], v53 offset:608
    s_waitcnt lgkmcnt(8)
    v_pk_fma_f32 v[64:65], v[32:33], v[54:55], v[64:65] op_sel:[0,0,0] op_sel_hi:[1,0,1]
    v_pk_fma_f32 v[66:67], v[34:35], v[54:55], v[66:67] op_sel:[0,0,0] op_sel_hi:[1,0,1]
    v_pk_fma_f32 v[68:69], v[36:37], v[54:55], v[68:69] op_sel:[0,0,0] op_sel_hi:[1,0,1]
    v_pk_fma_f32 v[70:71], v[38:39], v[54:55], v[70:71] op_sel:[0,0,0] op_sel_hi:[1,0,1]
    v_pk_mul_f32 v[64:65], v[64:65], v[16:17]
    v_pk_mul_f32 v[66:67], v[66:67], v[18:19]
    v_pk_mul_f32 v[68:69], v[68:69], v[20:21]
    v_pk_mul_f32 v[70:71], v[70:71], v[22:23]
    v_cvt_pk_bf16_f32 v64, v64, v65
    v_cvt_pk_bf16_f32 v65, v66, v67
    v_cvt_pk_bf16_f32 v66, v68, v69
    v_cvt_pk_bf16_f32 v67, v70, v71
    buffer_store_dwordx4 v[64:67], v128, s[20:23], s40 offen sc1
    v_pk_fma_f32 v[72:73], v[40:41], v[54:55], v[72:73] op_sel:[0,0,0] op_sel_hi:[1,0,1]
    v_pk_fma_f32 v[74:75], v[42:43], v[54:55], v[74:75] op_sel:[0,0,0] op_sel_hi:[1,0,1]
    v_pk_fma_f32 v[76:77], v[44:45], v[54:55], v[76:77] op_sel:[0,0,0] op_sel_hi:[1,0,1]
    v_pk_fma_f32 v[78:79], v[46:47], v[54:55], v[78:79] op_sel:[0,0,0] op_sel_hi:[1,0,1]
    v_pk_mul_f32 v[72:73], v[72:73], v[24:25]
    v_pk_mul_f32 v[74:75], v[74:75], v[26:27]
    v_pk_mul_f32 v[76:77], v[76:77], v[28:29]
    v_pk_mul_f32 v[78:79], v[78:79], v[30:31]
    v_cvt_pk_bf16_f32 v72, v72, v73
    v_cvt_pk_bf16_f32 v73, v74, v75
    v_cvt_pk_bf16_f32 v74, v76, v77
    v_cvt_pk_bf16_f32 v75, v78, v79
    buffer_store_dwordx4 v[72:75], v128, s[20:23], s41 offen sc1
    v_pk_fma_f32 v[80:81], v[32:33], v[58:59], v[80:81] op_sel:[0,0,0] op_sel_hi:[1,0,1]
    v_pk_fma_f32 v[82:83], v[34:35], v[58:59], v[82:83] op_sel:[0,0,0] op_sel_hi:[1,0,1]
    v_pk_fma_f32 v[84:85], v[36:37], v[58:59], v[84:85] op_sel:[0,0,0] op_sel_hi:[1,0,1]
    v_pk_fma_f32 v[86:87], v[38:39], v[58:59], v[86:87] op_sel:[0,0,0] op_sel_hi:[1,0,1]
    v_pk_mul_f32 v[80:81], v[80:81], v[16:17]
    v_pk_mul_f32 v[82:83], v[82:83], v[18:19]
    v_pk_mul_f32 v[84:85], v[84:85], v[20:21]
    v_pk_mul_f32 v[86:87], v[86:87], v[22:23]
    v_cvt_pk_bf16_f32 v80, v80, v81
    v_cvt_pk_bf16_f32 v81, v82, v83
    v_cvt_pk_bf16_f32 v82, v84, v85
    v_cvt_pk_bf16_f32 v83, v86, v87
    buffer_store_dwordx4 v[80:83], v129, s[20:23], s40 offen sc1
    v_pk_fma_f32 v[88:89], v[40:41], v[58:59], v[88:89] op_sel:[0,0,0] op_sel_hi:[1,0,1]
    v_pk_fma_f32 v[90:91], v[42:43], v[58:59], v[90:91] op_sel:[0,0,0] op_sel_hi:[1,0,1]
    v_pk_fma_f32 v[92:93], v[44:45], v[58:59], v[92:93] op_sel:[0,0,0] op_sel_hi:[1,0,1]
    v_pk_fma_f32 v[94:95], v[46:47], v[58:59], v[94:95] op_sel:[0,0,0] op_sel_hi:[1,0,1]
    v_pk_mul_f32 v[88:89], v[88:89], v[24:25]
    v_pk_mul_f32 v[90:91], v[90:91], v[26:27]
    v_pk_mul_f32 v[92:93], v[92:93], v[28:29]
    v_pk_mul_f32 v[94:95], v[94:95], v[30:31]
    v_cvt_pk_bf16_f32 v88, v88, v89
    v_cvt_pk_bf16_f32 v89, v90, v91
    v_cvt_pk_bf16_f32 v90, v92, v93
    v_cvt_pk_bf16_f32 v91, v94, v95
    buffer_store_dwordx4 v[88:91], v129, s[20:23], s41 offen sc1
    s_waitcnt lgkmcnt(0)
    v_pk_fma_f32 v[96:97], v[160:161], v[54:55], v[96:97] op_sel:[0,0,0] op_sel_hi:[1,0,1]
    v_pk_fma_f32 v[98:99], v[162:163], v[54:55], v[98:99] op_sel:[0,0,0] op_sel_hi:[1,0,1]
    v_pk_fma_f32 v[100:101], v[164:165], v[54:55], v[100:101] op_sel:[0,0,0] op_sel_hi:[1,0,1]
    v_pk_fma_f32 v[102:103], v[166:167], v[54:55], v[102:103] op_sel:[0,0,0] op_sel_hi:[1,0,1]
    v_pk_mul_f32 v[96:97], v[96:97], v[144:145]
    v_pk_mul_f32 v[98:99], v[98:99], v[146:147]
    v_pk_mul_f32 v[100:101], v[100:101], v[148:149]
    v_pk_mul_f32 v[102:103], v[102:103], v[150:151]
    v_cvt_pk_bf16_f32 v96, v96, v97
    v_cvt_pk_bf16_f32 v97, v98, v99
    v_cvt_pk_bf16_f32 v98, v100, v101
    v_cvt_pk_bf16_f32 v99, v102, v103
    buffer_store_dwordx4 v[96:99], v128, s[20:23], s42 offen sc1
    v_pk_fma_f32 v[104:105], v[168:169], v[54:55], v[104:105] op_sel:[0,0,0] op_sel_hi:[1,0,1]
    v_pk_fma_f32 v[106:107], v[170:171], v[54:55], v[106:107] op_sel:[0,0,0] op_sel_hi:[1,0,1]
    v_pk_fma_f32 v[108:109], v[172:173], v[54:55], v[108:109] op_sel:[0,0,0] op_sel_hi:[1,0,1]
    v_pk_fma_f32 v[110:111], v[174:175], v[54:55], v[110:111] op_sel:[0,0,0] op_sel_hi:[1,0,1]
    v_pk_mul_f32 v[104:105], v[104:105], v[152:153]
    v_pk_mul_f32 v[106:107], v[106:107], v[154:155]
    v_pk_mul_f32 v[108:109], v[108:109], v[156:157]
    v_pk_mul_f32 v[110:111], v[110:111], v[158:159]
    v_cvt_pk_bf16_f32 v104, v104, v105
    v_cvt_pk_bf16_f32 v105, v106, v107
    v_cvt_pk_bf16_f32 v106, v108, v109
    v_cvt_pk_bf16_f32 v107, v110, v111
    buffer_store_dwordx4 v[104:107], v128, s[20:23], s43 offen sc1
    v_pk_fma_f32 v[112:113], v[160:161], v[58:59], v[112:113] op_sel:[0,0,0] op_sel_hi:[1,0,1]
    v_pk_fma_f32 v[114:115], v[162:163], v[58:59], v[114:115] op_sel:[0,0,0] op_sel_hi:[1,0,1]
    v_pk_fma_f32 v[116:117], v[164:165], v[58:59], v[116:117] op_sel:[0,0,0] op_sel_hi:[1,0,1]
    v_pk_fma_f32 v[118:119], v[166:167], v[58:59], v[118:119] op_sel:[0,0,0] op_sel_hi:[1,0,1]
    v_pk_mul_f32 v[112:113], v[112:113], v[144:145]
    v_pk_mul_f32 v[114:115], v[114:115], v[146:147]
    v_pk_mul_f32 v[116:117], v[116:117], v[148:149]
    v_pk_mul_f32 v[118:119], v[118:119], v[150:151]
    v_cvt_pk_bf16_f32 v112, v112, v113
    v_cvt_pk_bf16_f32 v113, v114, v115
    v_cvt_pk_bf16_f32 v114, v116, v117
    v_cvt_pk_bf16_f32 v115, v118, v119
    buffer_store_dwordx4 v[112:115], v129, s[20:23], s42 offen sc1
    v_pk_fma_f32 v[120:121], v[168:169], v[58:59], v[120:121] op_sel:[0,0,0] op_sel_hi:[1,0,1]
    v_pk_fma_f32 v[122:123], v[170:171], v[58:59], v[122:123] op_sel:[0,0,0] op_sel_hi:[1,0,1]
    v_pk_fma_f32 v[124:125], v[172:173], v[58:59], v[124:125] op_sel:[0,0,0] op_sel_hi:[1,0,1]
    v_pk_fma_f32 v[126:127], v[174:175], v[58:59], v[126:127] op_sel:[0,0,0] op_sel_hi:[1,0,1]
    v_pk_mul_f32 v[120:121], v[120:121], v[152:153]
    v_pk_mul_f32 v[122:123], v[122:123], v[154:155]
    v_pk_mul_f32 v[124:125], v[124:125], v[156:157]
    v_pk_mul_f32 v[126:127], v[126:127], v[158:159]
    v_cvt_pk_bf16_f32 v120, v120, v121
    v_cvt_pk_bf16_f32 v121, v122, v123
    v_cvt_pk_bf16_f32 v122, v124, v125
    v_cvt_pk_bf16_f32 v123, v126, v127
    buffer_store_dwordx4 v[120:123], v129, s[20:23], s43 offen sc1
    s_branch K2_CT
K1_SPARE:
    s_cmp_ge_u32 s26, 2
    s_cbranch_scc1 K1_S2
    s_waitcnt lgkmcnt(0)
    s_mov_b32 s12, s4
    s_mov_b32 s13, s5
    s_mov_b32 s14, 0x280000
    s_mov_b32 s15, 0x00020000
    s_mov_b32 s40, s44
    s_mov_b32 s41, s45
    s_mov_b32 s42, 0x100
    s_mov_b32 s43, 0x00020000
    s_mov_b32 s20, s8
    s_mov_b32 s21, s9
    s_mov_b32 s22, 0xe4c400
    s_mov_b32 s23, 0x00020000
    s_lshl_b32 s27, s24, 7
    s_lshl_b32 s28, s26, 2
    s_add_u32 s27, s27, s28
    s_add_u32 s27, s27, 120
    v_lshrrev_b32 v3, 4, v1
    v_and_b32 v7, 15, v1
    v_add_u32 v2, s27, v3
    v_mul_u32_u24 v4, 1280, v2
    v_lshl_add_u32 v4, v7, 4, v4
    buffer_load_dwordx4 v[16:19], v4, s[12:15], 0 offen offset:0
    buffer_load_dwordx4 v[20:23], v4, s[12:15], 0 offen offset:256
    buffer_load_dwordx4 v[24:27], v4, s[12:15], 0 offen offset:512
    buffer_load_dwordx4 v[28:31], v4, s[12:15], 0 offen offset:768
    buffer_load_dwordx4 v[32:35], v4, s[12:15], 0 offen offset:1024
    buffer_load_dword v36, off, s[40:43], 0 sc1
    v_lshlrev_b32 v2, 4, v2
    v_lshl_or_b32 v2, v7, 28, v2
    s_mov_b32 s36, 14026752
    s_waitcnt vmcnt(0)
    v_readfirstlane_b32 s34, v36
    s_mov_b32 s48, 262144
    s_cmp_lg_u32 s34, 0
    s_cbranch_scc1 K1_Ns1
K1_Ns0:
    s_sub_u32 s48, s48, 1
    s_cbranch_scc1 K1_Ns1
    buffer_load_dword v36, off, s[40:43], 0 sc1
    s_waitcnt vmcnt(0)
    v_readfirstlane_b32 s34, v36
    s_cmp_eq_u32 s34, 0
    s_cbranch_scc1 K1_Ns0
K1_Ns1:
    v_lshlrev_b32 v40, 16, v16
    v_and_b32 v16, 0xffff0000, v16
    v_mul_f32 v41, v40, v40
    v_add_f32 v40, v40, v16
    v_fma_f32 v41, v16, v16, v41
    v_lshlrev_b32 v42, 16, v17
    v_and_b32 v17, 0xffff0000, v17
    v_add_f32 v40, v40, v42
    v_fma_f32 v41, v42, v42, v41
    v_add_f32 v40, v40, v17
    v_fma_f32 v41, v17, v17, v41
    v_lshlrev_b32 v42, 16, v18
    v_and_b32 v18, 0xffff0000, v18
    v_add_f32 v40, v40, v42
    v_fma_f32 v41, v42, v42, v41
    v_add_f32 v40, v40, v18
    v_fma_f32 v41, v18, v18, v41
    v_lshlrev_b32 v42, 16, v19
    v_and_b32 v19, 0xffff0000, v19
    v_add_f32 v40, v40, v42
    v_fma_f32 v41, v42, v42, v41
    v_add_f32 v40, v40, v19
    v_fma_f32 v41, v19, v19, v41
    v_lshlrev_b32 v42, 16, v20
    v_and_b32 v20, 0xffff0000, v20
    v_add_f32 v40, v40, v42
    v_fma_f32 v41, v42, v42, v41
    v_add_f32 v40, v40, v20
    v_fma_f32 v41, v20, v20, v41
    v_lshlrev_b32 v42, 16, v21
    v_and_b32 v21, 0xffff0000, v21
    v_add_f32 v40, v40, v42
    v_fma_f32 v41, v42, v42, v41
    v_add_f32 v40, v40, v21
    v_fma_f32 v41, v21, v21, v41
    v_lshlrev_b32 v42, 16, v22
    v_and_b32 v22, 0xffff0000, v22
    v_add_f32 v40, v40, v42
    v_fma_f32 v41, v42, v42, v41
    v_add_f32 v40, v40, v22
    v_fma_f32 v41, v22, v22, v41
    v_lshlrev_b32 v42, 16, v23
    v_and_b32 v23, 0xffff0000, v23
    v_add_f32 v40, v40, v42
    v_fma_f32 v41, v42, v42, v41
    v_add_f32 v40, v40, v23
    v_fma_f32 v41, v23, v23, v41
    v_lshlrev_b32 v42, 16, v24
    v_and_b32 v24, 0xffff0000, v24
    v_add_f32 v40, v40, v42
    v_fma_f32 v41, v42, v42, v41
    v_add_f32 v40, v40, v24
    v_fma_f32 v41, v24, v24, v41
    v_lshlrev_b32 v42, 16, v25
    v_and_b32 v25, 0xffff0000, v25
    v_add_f32 v40, v40, v42
    v_fma_f32 v41, v42, v42, v41
    v_add_f32 v40, v40, v25
    v_fma_f32 v41, v25, v25, v41
    v_lshlrev_b32 v42, 16, v26
    v_and_b32 v26, 0xffff0000, v26
    v_add_f32 v40, v40, v42
    v_fma_f32 v41, v42, v42, v41
    v_add_f32 v40, v40, v26
    v_fma_f32 v41, v26, v26, v41
    v_lshlrev_b32 v42, 16, v27
    v_and_b32 v27, 0xffff0000, v27
    v_add_f32 v40, v40, v42
    v_fma_f32 v41, v42, v42, v41
    v_add_f32 v40, v40, v27
    v_fma_f32 v41, v27, v27, v41
    v_lshlrev_b32 v42, 16, v28
    v_and_b32 v28, 0xffff0000, v28
    v_add_f32 v40, v40, v42
    v_fma_f32 v41, v42, v42, v41
    v_add_f32 v40, v40, v28
    v_fma_f32 v41, v28, v28, v41
    v_lshlrev_b32 v42, 16, v29
    v_and_b32 v29, 0xffff0000, v29
    v_add_f32 v40, v40, v42
    v_fma_f32 v41, v42, v42, v41
    v_add_f32 v40, v40, v29
    v_fma_f32 v41, v29, v29, v41
    v_lshlrev_b32 v42, 16, v30
    v_and_b32 v30, 0xffff0000, v30
    v_add_f32 v40, v40, v42
    v_fma_f32 v41, v42, v42, v41
    v_add_f32 v40, v40, v30
    v_fma_f32 v41, v30, v30, v41
    v_lshlrev_b32 v42, 16, v31
    v_and_b32 v31, 0xffff0000, v31
    v_add_f32 v40, v40, v42
    v_fma_f32 v41, v42, v42, v41
    v_add_f32 v40, v40, v31
    v_fma_f32 v41, v31, v31, v41
    v_lshlrev_b32 v42, 16, v32
    v_and_b32 v32, 0xffff0000, v32
    v_add_f32 v40, v40, v42
    v_fma_f32 v41, v42, v42, v41
    v_add_f32 v40, v40, v32
    v_fma_f32 v41, v32, v32, v41
    v_lshlrev_b32 v42, 16, v33
    v_and_b32 v33, 0xffff0000, v33
    v_add_f32 v40, v40, v42
    v_fma_f32 v41, v42, v42, v41
    v_add_f32 v40, v40, v33
    v_fma_f32 v41, v33, v33, v41
    v_lshlrev_b32 v42, 16, v34
    v_and_b32 v34, 0xffff0000, v34
    v_add_f32 v40, v40, v42
    v_fma_f32 v41, v42, v42, v41
    v_add_f32 v40, v40, v34
    v_fma_f32 v41, v34, v34, v41
    v_lshlrev_b32 v42, 16, v35
    v_and_b32 v35, 0xffff0000, v35
    v_add_f32 v40, v40, v42
    v_fma_f32 v41, v42, v42, v41
    v_add_f32 v40, v40, v35
    v_fma_f32 v41, v35, v35, v41
    s_nop 0
    v_add_f32_dpp v40, v40, v40 row_ror:8 row_mask:0xf bank_mask:0xf
    v_add_f32_dpp v41, v41, v41 row_ror:8 row_mask:0xf bank_mask:0xf
    s_nop 0
    v_add_f32_dpp v40, v40, v40 row_ror:4 row_mask:0xf bank_mask:0xf
    v_add_f32_dpp v41, v41, v41 row_ror:4 row_mask:0xf bank_mask:0xf
    s_nop 0
    v_add_f32_dpp v40, v40, v40 row_ror:2 row_mask:0xf bank_mask:0xf
    v_add_f32_dpp v41, v41, v41 row_ror:2 row_mask:0xf bank_mask:0xf
    s_nop 0
    v_add_f32_dpp v40, v40, v40 row_ror:1 row_mask:0xf bank_mask:0xf
    v_add_f32_dpp v41, v41, v41 row_ror:1 row_mask:0xf bank_mask:0xf
    v_mul_f32 v46, 0xbacccccd, v40
    v_mul_f32 v41, 0x3acccccd, v41
    v_fma_f32 v41, -v46, v46, v41
    v_max_f32 v41, 0, v41
    v_add_f32 v41, 0x3727c5ac, v41
    v_rsq_f32 v44, v41
    v_mov_b32 v45, s34
    v_mov_b32 v47, s34
    buffer_store_dwordx4 v[44:47], v2, s[20:23], s36 offen sc1
    s_cmp_lg_u32 s26, 0
    s_cbranch_scc1 K1_S2
    v_mov_b32 v40, 0
    v_mov_b32 v41, 0
    v_mov_b32 v42, 0
    v_mov_b32 v43, s34
    v_mov_b32 v48, 163776
    ds_write_b128 v48, v[40:43]
    ds_write_b32 v48, v40 offset:16
K1_S2:
    s_load_dwordx2 s[40:41], s[0:1], 16
    s_load_dwordx2 s[42:43], s[0:1], 32
    v_lshlrev_b32 v11, 4, v1
    s_mul_i32 s27, s24, 51200
    s_lshl_b32 s28, s26, 10
    s_add_u32 s27, s27, s28
    v_mov_b32 v8, 0x80000000
    s_waitcnt lgkmcnt(0)
    s_mov_b32 s12, s40
    s_mov_b32 s13, s41
    s_mov_b32 s14, 0xc8000
    s_mov_b32 s15, 0x00020000
    s_mov_b32 s16, s42
    s_mov_b32 s17, s43
    s_mov_b32 s18, 0x500
    s_mov_b32 s19, 0x00020000
    s_mov_b32 s20, s8
    s_mov_b32 s21, s9
    s_mov_b32 s22, 0xe4c400
    s_mov_b32 s23, 0x00020000
    s_add_u32 m0, s28, 0
    s_add_u32 s29, s27, 0
    buffer_load_dwordx4 v11, s[12:15], s29 offen lds
    s_add_u32 m0, s28, 8192
    s_add_u32 s29, s27, 8192
    buffer_load_dwordx4 v11, s[12:15], s29 offen lds
    s_add_u32 m0, s28, 16384
    s_add_u32 s29, s27, 16384
    buffer_load_dwordx4 v11, s[12:15], s29 offen lds
    s_add_u32 m0, s28, 24576
    s_add_u32 s29, s27, 24576
    buffer_load_dwordx4 v11, s[12:15], s29 offen lds
    s_add_u32 m0, s28, 32768
    s_add_u32 s29, s27, 32768
    buffer_load_dwordx4 v11, s[12:15], s29 offen lds
    s_add_u32 m0, s28, 40960
    s_add_u32 s29, s27, 40960
    buffer_load_dwordx4 v11, s[12:15], s29 offen lds
    s_cmp_ge_u32 s26, 2
    s_cbranch_scc1 K1_S3
    s_add_u32 m0, s28, 49152
    s_add_u32 s29, s27, 49152
    buffer_load_dwordx4 v11, s[12:15], s29 offen lds
K1_S3:
    buffer_load_dwordx4 v[48:51], v11, s[16:19], 0 offen
    buffer_load_dwordx4 v[52:55], v11, s[16:19], 0 offen offset:1024
    s_lshl_b32 s27, s24, 1
    v_add_u32 v12, s27, v0
    s_mov_b32 s28, 82048
    v_mul_u32_u24 v13, s28, v12
    v_add_u32 v13, 5324800, v13
    v_cmp_gt_u32 vcc, 2, v0
    s_nop 1
    v_cndmask_b32 v13, v8, v13, vcc
    v_mov_b32 v56, 0x3f803f80
    v_mov_b32 v57, 0x3f803f80
    v_mov_b32 v58, 0x3f803f80
    v_mov_b32 v59, 0x3f803f80
    buffer_store_dwordx4 v[56:59], v13, s[20:23], 0 offen sc1
    v_lshrrev_b32 v2, 4, v1
    v_bfe_u32 v3, v1, 2, 2
    v_mul_u32_u24 v3, 1280, v3
    v_and_b32 v4, 3, v1
    v_mul_u32_u24 v4, 40, v4
    v_add_u32 v3, v3, v4
    s_mul_i32 s27, s26, 160
    v_add_u32 v3, s27, v3
    v_and_b32 v4, 15, v1
    v_lshlrev_b32 v4, 4, v4
    s_mul_i32 s27, s26, 102400
    s_add_u32 s27, s27, 13144064
    v_add_u32 v4, s27, v4
    s_lshr_b32 s28, s24, 2
    s_mul_i32 s28, s28, 20
    s_and_b32 s29, s24, 3
    s_add_u32 s30, s28, s29
    s_add_u32 s30, s30, 16
    v_mov_b32 v10, s30
    s_lshl_b32 s29, s29, 2
    s_add_u32 s28, s28, s29
    v_add_u32 v5, 0, v2
    v_mul_u32_u24 v6, 52, v5
    v_lshrrev_b32 v6, 8, v6
    v_mul_u32_u24 v7, 5, v6
    v_sub_u32 v7, v5, v7
    v_mul_u32_u24 v9, 10240, v6
    v_lshl_add_u32 v9, v7, 3, v9
    v_add_u32 v60, v9, v3
    v_cmp_eq_u32 vcc, 2, v6
    v_mad_u32_u24 v6, v6, 3, 1
    v_lshrrev_b32 v6, 2, v6
    v_add_u32 v6, s28, v6
    v_cndmask_b32 v6, v6, v10, vcc
    v_lshrrev_b32 v9, 2, v6
    v_mul_u32_u24 v9, 5, v9
    v_add_u32 v9, v9, v7
    v_lshl_add_u32 v9, v9, 10, v4
    v_and_b32 v6, 3, v6
    v_lshl_add_u32 v68, v6, 8, v9
    v_add_u32 v5, 4, v2
    v_mul_u32_u24 v6, 52, v5
    v_lshrrev_b32 v6, 8, v6
    v_mul_u32_u24 v7, 5, v6
    v_sub_u32 v7, v5, v7
    v_mul_u32_u24 v9, 10240, v6
    v_lshl_add_u32 v9, v7, 3, v9
    v_add_u32 v61, v9, v3
    v_cmp_eq_u32 vcc, 2, v6
    v_mad_u32_u24 v6, v6, 3, 1
    v_lshrrev_b32 v6, 2, v6
    v_add_u32 v6, s28, v6
    v_cndmask_b32 v6, v6, v10, vcc
    v_lshrrev_b32 v9, 2, v6
    v_mul_u32_u24 v9, 5, v9
    v_add_u32 v9, v9, v7
    v_lshl_add_u32 v9, v9, 10, v4
    v_and_b32 v6, 3, v6
    v_lshl_add_u32 v69, v6, 8, v9
    v_add_u32 v5, 8, v2
    v_mul_u32_u24 v6, 52, v5
    v_lshrrev_b32 v6, 8, v6
    v_mul_u32_u24 v7, 5, v6
    v_sub_u32 v7, v5, v7
    v_mul_u32_u24 v9, 10240, v6
    v_lshl_add_u32 v9, v7, 3, v9
    v_add_u32 v62, v9, v3
    v_cmp_eq_u32 vcc, 2, v6
    v_mad_u32_u24 v6, v6, 3, 1
    v_lshrrev_b32 v6, 2, v6
    v_add_u32 v6, s28, v6
    v_cndmask_b32 v6, v6, v10, vcc
    v_lshrrev_b32 v9, 2, v6
    v_mul_u32_u24 v9, 5, v9
    v_add_u32 v9, v9, v7
    v_lshl_add_u32 v9, v9, 10, v4
    v_and_b32 v6, 3, v6
    v_lshl_add_u32 v70, v6, 8, v9
    v_add_u32 v5, 12, v2
    v_mul_u32_u24 v6, 52, v5
    v_lshrrev_b32 v6, 8, v6
    v_mul_u32_u24 v7, 5, v6
    v_sub_u32 v7, v5, v7
    v_mul_u32_u24 v9, 10240, v6
    v_lshl_add_u32 v9, v7, 3, v9
    v_add_u32 v63, v9, v3
    v_cmp_eq_u32 vcc, 2, v6
    v_mad_u32_u24 v6, v6, 3, 1
    v_lshrrev_b32 v6, 2, v6
    v_add_u32 v6, s28, v6
    v_cndmask_b32 v6, v6, v10, vcc
    v_lshrrev_b32 v9, 2, v6
    v_mul_u32_u24 v9, 5, v9
    v_add_u32 v9, v9, v7
    v_lshl_add_u32 v9, v9, 10, v4
    v_and_b32 v6, 3, v6
    v_lshl_add_u32 v71, v6, 8, v9
    v_add_u32 v5, 16, v2
    v_mul_u32_u24 v6, 52, v5
    v_lshrrev_b32 v6, 8, v6
    v_mul_u32_u24 v7, 5, v6
    v_sub_u32 v7, v5, v7
    v_mul_u32_u24 v9, 10240, v6
    v_lshl_add_u32 v9, v7, 3, v9
    v_add_u32 v64, v9, v3
    v_cmp_eq_u32 vcc, 2, v6
    v_mad_u32_u24 v6, v6, 3, 1
    v_lshrrev_b32 v6, 2, v6
    v_add_u32 v6, s28, v6
    v_cndmask_b32 v6, v6, v10, vcc
    v_lshrrev_b32 v9, 2, v6
    v_mul_u32_u24 v9, 5, v9
    v_add_u32 v9, v9, v7
    v_lshl_add_u32 v9, v9, 10, v4
    v_and_b32 v6, 3, v6
    v_lshl_add_u32 v72, v6, 8, v9
    v_add_u32 v5, 20, v2
    v_mul_u32_u24 v6, 52, v5
    v_lshrrev_b32 v6, 8, v6
    v_mul_u32_u24 v7, 5, v6
    v_sub_u32 v7, v5, v7
    v_mul_u32_u24 v9, 10240, v6
    v_lshl_add_u32 v9, v7, 3, v9
    v_add_u32 v65, v9, v3
    v_cmp_eq_u32 vcc, 2, v6
    v_mad_u32_u24 v6, v6, 3, 1
    v_lshrrev_b32 v6, 2, v6
    v_add_u32 v6, s28, v6
    v_cndmask_b32 v6, v6, v10, vcc
    v_lshrrev_b32 v9, 2, v6
    v_mul_u32_u24 v9, 5, v9
    v_add_u32 v9, v9, v7
    v_lshl_add_u32 v9, v9, 10, v4
    v_and_b32 v6, 3, v6
    v_lshl_add_u32 v73, v6, 8, v9
    v_add_u32 v5, 24, v2
    v_mul_u32_u24 v6, 52, v5
    v_lshrrev_b32 v6, 8, v6
    v_mul_u32_u24 v7, 5, v6
    v_sub_u32 v7, v5, v7
    v_mul_u32_u24 v9, 10240, v6
    v_lshl_add_u32 v9, v7, 3, v9
    v_add_u32 v66, v9, v3
    v_cmp_eq_u32 vcc, 2, v6
    v_mad_u32_u24 v6, v6, 3, 1
    v_lshrrev_b32 v6, 2, v6
    v_add_u32 v6, s28, v6
    v_cndmask_b32 v6, v6, v10, vcc
    v_lshrrev_b32 v9, 2, v6
    v_mul_u32_u24 v9, 5, v9
    v_add_u32 v9, v9, v7
    v_lshl_add_u32 v9, v9, 10, v4
    v_and_b32 v6, 3, v6
    v_lshl_add_u32 v74, v6, 8, v9
    v_cmp_gt_u32 vcc, 25, v5
    s_nop 1
    v_cndmask_b32 v74, v8, v74, vcc
    v_cndmask_b32 v66, v3, v66, vcc
    s_waitcnt vmcnt(0) lgkmcnt(0)
    s_barrier
    ds_read_b64_tr_b16 v[16:17], v60
    ds_read_b64_tr_b16 v[18:19], v60 offset:5120
    ds_read_b64_tr_b16 v[20:21], v61
    ds_read_b64_tr_b16 v[22:23], v61 offset:5120
    ds_read_b64_tr_b16 v[24:25], v62
    ds_read_b64_tr_b16 v[26:27], v62 offset:5120
    ds_read_b64_tr_b16 v[28:29], v63
    ds_read_b64_tr_b16 v[30:31], v63 offset:5120
    ds_read_b64_tr_b16 v[32:33], v64
    ds_read_b64_tr_b16 v[34:35], v64 offset:5120
    ds_read_b64_tr_b16 v[36:37], v65
    ds_read_b64_tr_b16 v[38:39], v65 offset:5120
    ds_read_b64_tr_b16 v[40:41], v66
    ds_read_b64_tr_b16 v[42:43], v66 offset:5120
    s_waitcnt lgkmcnt(12)
    buffer_store_dwordx4 v[16:19], v68, s[20:23], 0 offen sc1
    s_waitcnt lgkmcnt(10)
    buffer_store_dwordx4 v[20:23], v69, s[20:23], 0 offen sc1
    s_waitcnt lgkmcnt(8)
    buffer_store_dwordx4 v[24:27], v70, s[20:23], 0 offen sc1
    s_waitcnt lgkmcnt(6)
    buffer_store_dwordx4 v[28:31], v71, s[20:23], 0 offen sc1
    s_waitcnt lgkmcnt(4)
    buffer_store_dwordx4 v[32:35], v72, s[20:23], 0 offen sc1
    s_waitcnt lgkmcnt(2)
    buffer_store_dwordx4 v[36:39], v73, s[20:23], 0 offen sc1
    s_waitcnt lgkmcnt(0)
    buffer_store_dwordx4 v[40:43], v74, s[20:23], 0 offen sc1
    s_mov_b32 s29, 0x3f803f80
    v_mov_b32 v2, 0
    v_dot2c_f32_bf16 v2, s29, v48
    v_dot2c_f32_bf16 v2, s29, v49
    v_dot2c_f32_bf16 v2, s29, v50
    v_dot2c_f32_bf16 v2, s29, v51
    v_dot2c_f32_bf16 v2, s29, v52
    v_dot2c_f32_bf16 v2, s29, v53
    v_dot2c_f32_bf16 v2, s29, v54
    v_dot2c_f32_bf16 v2, s29, v55
    s_nop 2
    v_add_f32_dpp v2, v2, v2 quad_perm:[1,0,3,2] row_mask:0xf bank_mask:0xf
    s_nop 1
    v_add_f32_dpp v2, v2, v2 quad_perm:[2,3,0,1] row_mask:0xf bank_mask:0xf
    s_nop 1
    v_add_f32_dpp v2, v2, v2 row_half_mirror row_mask:0xf bank_mask:0xf
    s_nop 1
    v_add_f32_dpp v2, v2, v2 row_mirror row_mask:0xf bank_mask:0xf
    s_nop 1
    v_mov_b32 v3, v2
    s_nop 1
    v_permlane16_swap_b32 v2, v3
    v_add_f32 v2, v2, v3
    v_mov_b32 v3, v2
    s_nop 1
    v_permlane32_swap_b32 v2, v3
    v_add_f32 v2, v2, v3
    s_lshl_b32 s27, s24, 9
    v_add_u32 v12, s27, v0
    v_cmp_eq_u32 vcc, 0, v12
    v_mov_b32 v13, 14018560
    s_nop 0
    v_cndmask_b32 v13, v8, v13, vcc
    buffer_store_dword v2, v13, s[20:23], 0 offen sc1
    s_mov_b64 exec, -1
    v_mov_b32 v191, 163776
    ds_read_b32 v60, v191 offset:12
    s_waitcnt vmcnt(0) lgkmcnt(0)
    s_barrier
    v_readfirstlane_b32 s33, v60
    s_cmp_lt_u32 s26, 4
    s_cbranch_scc1 K1_S5
    v_and_b32 v1, 63, v0
    s_cmp_lg_u32 s26, 6
    s_cbranch_scc1 K2_LT
    s_lshl_b32 s50, s3, 2
    s_and_b32 s51, s10, 3
    s_add_u32 s50, s50, s51
    s_lshr_b32 s53, s50, 1
    s_mul_i32 s50, s50, 20
    s_add_u32 s51, s50, 19
    s_lshr_b32 s50, s50, 7
    s_lshr_b32 s51, s51, 7
    s_sub_u32 s51, s51, s50
    s_lshr_b32 s52, s10, 2
    s_lshl_b32 s52, s52, 1
    v_mov_b32 v220, 0
    v_lshrrev_b32 v214, 2, v1
    v_and_b32 v213, 3, v1
    v_and_b32 v215, 1, v214
    v_lshrrev_b32 v212, 1, v214
    v_mad_u32_u24 v212, v212, 5, 5
    v_cmp_eq_u32 vcc, 4, v214
    v_lshrrev_b32 v218, 1, v213
    v_and_b32 v217, 1, v213
    v_add_u32 v217, s52, v217
    v_cndmask_b32 v215, v215, v218, vcc
    v_cndmask_b32 v213, v213, v217, vcc
    v_cndmask_b32 v212, v212, v220, vcc
    v_mad_u32_u24 v212, v215, s51, v212
    v_add_u32 v212, s50, v212
    v_cmp_lt_u32 vcc, 4, v214
    v_mov_b32 v217, s53
    v_mov_b32 v218, 15
    v_cndmask_b32 v213, v213, v217, vcc
    v_cndmask_b32 v212, v212, v218, vcc
    v_lshl_add_u32 v212, v213, 4, v212
    v_lshlrev_b32 v212, 7, v212
    v_add_u32 v216, 14587904, v212
    v_bfe_u32 v215, v1, 4, 1
    v_lshrrev_b32 v212, 5, v1
    v_mad_u32_u24 v212, v212, 5, 5
    v_mad_u32_u24 v212, v215, s51, v212
    v_add_u32 v212, s50, v212
    v_and_b32 v213, 15, v1
    v_lshl_add_u32 v212, v213, 4, v212
    v_lshlrev_b32 v212, 7, v212
    v_add_u32 v217, 14587904, v212
    v_mov_b32 v212, 15
    v_and_b32 v213, 15, v1
    v_lshl_add_u32 v212, v213, 4, v212
    v_lshlrev_b32 v212, 7, v212
    v_add_u32 v218, 14587904, v212
    v_lshrrev_b32 v214, 2, v1
    v_and_b32 v213, 3, v1
    s_lshl_b32 s52, s3, 2
    v_add_u32 v213, s52, v213
    v_lshl_add_u32 v213, v213, 3, v214
    v_lshlrev_b32 v213, 7, v213
    v_add_u32 v213, 14587968, v213
    v_cmp_gt_u32 vcc, 32, v1
    s_nop 1
    v_cndmask_b32 v218, v218, v213, vcc
    buffer_load_dword v219, v216, s[20:23], 0 offen sc1
    s_waitcnt vmcnt(0)
    s_branch K2_LP
K1_S5:
    v_and_b32 v192, 31, v0
    v_bfe_u32 v193, v0, 5, 1
    v_and_b32 v184, 63, v0
    v_lshlrev_b32 v184, 4, v184
    v_lshlrev_b32 v194, 4, v192
    v_add_u32 v185, 2048, v194
    v_mul_u32_u24 v186, 336, v193
    v_add3_u32 v186, v186, v185, 0
    v_add_u32 v186, 512, v186
    v_lshl_add_u32 v187, v193, 3, v185
    v_lshl_or_b32 v185, v193, 30, v185
    v_add_u32 v194, 11, v192
    v_lshrrev_b32 v194, 5, v194
    v_lshl_or_b32 v186, v194, 30, v186
    v_lshrrev_b32 v194, 4, v192
    v_and_b32 v195, 15, v0
    v_lshlrev_b32 v195, 4, v195
    v_lshl_add_u32 v180, v194, 14, v195
    v_lshl_add_u32 v180, v193, 8, v180
    v_lshl_add_u32 v181, v194, 13, v195
    v_lshl_or_b32 v181, v193, 31, v181
    v_mov_b32 v191, 163776
    s_lshl_b32 s101, s3, 2
    s_and_b32 s46, s10, 3
    s_add_u32 s101, s101, s46
    s_mul_i32 s96, s101, 81920
    s_add_u32 s96, s96, 2621440
    s_lshr_b32 s46, s10, 2
    s_lshl_b32 s46, s46, 2
    s_add_u32 s46, s46, s26
    s_mul_i32 s97, s101, 81920
    s_mul_i32 s47, s46, 2560
    s_add_u32 s97, s97, s47
    s_mul_i32 s98, s46, 81920
    s_add_u32 s98, s98, 7868416
    s_lshl_b32 s47, s101, 8
    s_add_u32 s98, s98, s47
    s_add_u32 s99, s98, 65536
    s_add_u32 s98, s98, s47
    s_lshl_b32 s100, s24, 4
    s_add_u32 s100, s100, s25
    s_lshl_b32 s100, s100, 7
    s_add_u32 s100, s100, 14587904
    v_and_b32 v189, 7, v0
    v_lshlrev_b32 v189, 15, v189
    s_and_b32 s46, s101, 1
    s_lshl_b32 s46, s46, 2
    s_mul_i32 s47, s101, 320
    v_and_b32 v188, 0x13, v192
    v_and_b32 v194, 4, v192
    v_lshl_add_u32 v188, v194, 1, v188
    v_bfe_u32 v194, v192, 3, 1
    v_lshl_add_u32 v188, v194, 2, v188
    v_add_u32 v188, s46, v188
    v_subrev_u32 v194, 20, v188
    v_min_u32 v188, v188, v194
    v_lshl_add_u32 v188, v188, 4, s47
    v_mul_u32_u24 v194, 10240, v193
    v_add_u32 v188, v188, v194
    s_mov_b32 s14, s26
    s_mov_b32 s6, s10
    s_mov_b64 s[4:5], s[8:9]
    s_mov_b32 s10, 0xe4c400
    s_mov_b32 s11, 0x00020000
    s_mov_b32 s12, s101
    s_mov_b32 s15, s96
    s_mov_b32 s17, s97
    s_mov_b32 s24, s98
    s_add_u32 s25, s98, 32768
    s_mov_b32 s27, s99
    s_mov_b32 s22, 0
    s_mov_b32 s20, -4
    s_mov_b32 s21, 4
    v_mov_b32 v4, v184
    v_mov_b32 v5, v185
    v_mov_b32 v6, v186
    v_mov_b32 v3, v187
    v_mov_b32 v7, v188
    s_cmp_lg_u32 s14, 0
    s_cbranch_scc1 K2_CW
    s_mov_b64 exec, 1
    v_mov_b32 v61, s33
    buffer_store_dword v61, off, s[8:11], s100 sc1
    s_mov_b64 exec, -1
    s_branch K2_CW
K1_END:
    s_endpgm
K2_LT:
    s_lshl_b32 s50, s3, 2
    s_and_b32 s51, s10, 3
    s_add_u32 s50, s50, s51
    s_lshr_b32 s53, s50, 1
    s_mul_i32 s50, s50, 20
    s_add_u32 s51, s50, 19
    s_lshr_b32 s50, s50, 7
    s_lshr_b32 s51, s51, 7
    s_sub_u32 s51, s51, s50
    s_lshr_b32 s52, s10, 2
    s_lshl_b32 s52, s52, 1
    v_mov_b32 v220, 0
    v_lshrrev_b32 v214, 2, v1
    v_and_b32 v213, 3, v1
    v_and_b32 v215, 1, v214
    v_lshrrev_b32 v212, 1, v214
    v_mad_u32_u24 v212, v212, 5, 5
    v_cmp_eq_u32 vcc, 4, v214
    v_lshrrev_b32 v218, 1, v213
    v_and_b32 v217, 1, v213
    v_add_u32 v217, s52, v217
    v_cndmask_b32 v215, v215, v218, vcc
    v_cndmask_b32 v213, v213, v217, vcc
    v_cndmask_b32 v212, v212, v220, vcc
    v_mad_u32_u24 v212, v215, s51, v212
    v_add_u32 v212, s50, v212
    v_cmp_lt_u32 vcc, 4, v214
    v_mov_b32 v217, s53
    v_mov_b32 v218, 15
    v_cndmask_b32 v213, v213, v217, vcc
    v_cndmask_b32 v212, v212, v218, vcc
    v_lshl_add_u32 v212, v213, 4, v212
    v_lshlrev_b32 v212, 7, v212
    v_add_u32 v216, 14587904, v212
    s_setprio 0
    s_sub_u32 s14, s26, 4
    s_mov_b32 s6, s10
    s_mov_b64 s[4:5], s[8:9]
    s_mov_b32 s10, 0xe4c400
    s_mov_b32 s11, 0x00020000
    s_lshl_b32 s12, s3, 2
    s_and_b32 s7, s6, 3
    s_add_u32 s12, s12, s7
    s_mul_i32 s15, s12, 81920
    s_mul_i32 s17, s14, 2560
    s_add_u32 s17, s17, s15
    s_add_u32 s17, s17, 2624000
    s_mul_i32 s16, s14, 5248
    s_mul_i32 s18, s14, 82048
    s_add_u32 s18, s18, 5322880
    v_lshlrev_b32 v4, 4, v1
    v_mov_b32 v191, 163776
    v_lshrrev_b32 v12, 3, v1
    v_mul_u32_u24 v12, 20992, v12
    v_and_b32 v13, 7, v1
    v_mul_u32_u24 v13, 336, v13
    s_add_u32 s19, s16, 2880
    v_add3_u32 v12, v12, v13, s19
    v_mov_b32 v200, 0x3f803f80
    v_mov_b32 v201, 0x3f803f80
    v_mov_b32 v202, 0x3f803f80
    v_mov_b32 v203, 0x3f803f80
    s_cmp_eq_u32 s14, 3
    s_cselect_b32 s36, 0x00ffffff, -1
    v_add_u32 v5, 0, v1
    v_mul_u32_u24 v6, 3121, v5
    v_lshrrev_b32 v6, 16, v6
    v_mul_u32_u24 v7, 21, v6
    v_sub_u32 v5, v5, v7
    s_and_b32 s46, s12, 1
    s_lshl_b32 s46, s46, 2
    s_mul_i32 s47, s12, 320
    v_and_b32 v8, 0x13, v5
    v_and_b32 v7, 4, v5
    v_lshl_add_u32 v8, v7, 1, v8
    v_bfe_u32 v7, v5, 3, 1
    v_lshl_add_u32 v8, v7, 2, v8
    v_add_u32 v8, s46, v8
    v_subrev_u32 v7, 20, v8
    v_min_u32 v8, v8, v7
    v_lshl_add_u32 v8, v8, 4, s47
    v_mul_u32_u24 v6, 10240, v6
    v_add_u32 v8, v8, v6
    v_cmp_ne_u32 s[28:29], 20, v5
    v_add_u32 v8, 2048, v8
    v_add_u32 v5, 64, v1
    v_mul_u32_u24 v6, 3121, v5
    v_lshrrev_b32 v6, 16, v6
    v_mul_u32_u24 v7, 21, v6
    v_sub_u32 v5, v5, v7
    v_and_b32 v9, 0x13, v5
    v_and_b32 v7, 4, v5
    v_lshl_add_u32 v9, v7, 1, v9
    v_bfe_u32 v7, v5, 3, 1
    v_lshl_add_u32 v9, v7, 2, v9
    v_add_u32 v9, s46, v9
    v_subrev_u32 v7, 20, v9
    v_min_u32 v9, v9, v7
    v_lshl_add_u32 v9, v9, 4, s47
    v_mul_u32_u24 v6, 10240, v6
    v_add_u32 v9, v9, v6
    v_cmp_ne_u32 s[30:31], 20, v5
    v_add_u32 v9, 1024, v9
    v_add_u32 v5, 128, v1
    v_mul_u32_u24 v6, 3121, v5
    v_lshrrev_b32 v6, 16, v6
    v_mul_u32_u24 v7, 21, v6
    v_sub_u32 v5, v5, v7
    v_and_b32 v10, 0x13, v5
    v_and_b32 v7, 4, v5
    v_lshl_add_u32 v10, v7, 1, v10
    v_bfe_u32 v7, v5, 3, 1
    v_lshl_add_u32 v10, v7, 2, v10
    v_add_u32 v10, s46, v10
    v_subrev_u32 v7, 20, v10
    v_min_u32 v10, v10, v7
    v_lshl_add_u32 v10, v10, 4, s47
    v_mul_u32_u24 v6, 10240, v6
    v_add_u32 v10, v10, v6
    v_cmp_ne_u32 s[34:35], 20, v5
    v_add_u32 v10, 0, v10
    s_nop 4
    s_and_b32 s35, s35, 0xff
    s_add_u32 s52, s14, 1
    s_lshr_b32 s52, s52, 1
    s_lshl_b32 s52, 0x1111, s52
    s_mov_b32 s53, 0
    s_mov_b64 exec, s[52:53]
    buffer_load_dword v219, v216, s[20:23], 0 offen sc1
    s_waitcnt vmcnt(0)
    s_mov_b32 s48, 262144
K2_W1:
    v_cmp_ne_u32 vcc, s33, v219
    s_cbranch_vccz K2_W12
    s_sleep 4
    buffer_load_dword v219, v216, s[20:23], 0 offen sc1
    s_waitcnt vmcnt(0)
    s_sub_u32 s48, s48, 1
    s_cbranch_scc0 K2_W1
K2_W12:
    s_mov_b64 exec, -1
    s_mov_b32 m0, s16
    s_add_u32 s19, s16, 2560
    buffer_load_dwordx4 v4, s[8:11], s17 offen lds
    buffer_load_dwordx4 v4, s[8:11], s17 offen offset:1024 lds
    s_mov_b32 exec_hi, 0
    buffer_load_dwordx4 v4, s[8:11], s17 offen offset:2048 lds
    s_mov_b32 m0, s19
    s_mov_b64 exec, s[34:35]
    buffer_load_dwordx4 v10, s[8:11], s18 offen offset:2048 lds
    s_mov_b64 exec, s[28:29]
    buffer_load_dwordx4 v8, s[8:11], s18 offen lds
    s_mov_b64 exec, s[30:31]
    buffer_load_dwordx4 v9, s[8:11], s18 offen offset:1024 lds
    s_mov_b64 exec, -1
    s_add_u32 s16, s16, 20992
    s_add_u32 s17, s17, 10240
    s_add_u32 s18, s18, 328192
    s_mov_b64 exec, 0xff
    ds_write_b128 v12, v[200:203]
    s_mov_b64 exec, -1
    s_waitcnt vmcnt(0) lgkmcnt(0)
    s_barrier
    s_mov_b32 exec_lo, 0xffffff00
    s_mov_b32 exec_hi, s36
    ds_write_b128 v12, v[200:203]
    s_mov_b64 exec, -1
    s_mov_b32 s48, 262144
K2_W2:
    ds_read_b32 v219, v191 offset:8
    s_waitcnt lgkmcnt(0)
    v_readfirstlane_b32 s46, v219
    s_cmp_eq_u32 s46, s33
    s_cbranch_scc1 K2_W22
    s_sleep 1
    s_sub_u32 s48, s48, 1
    s_cbranch_scc0 K2_W2
K2_W22:
    s_mov_b32 m0, s16
    s_add_u32 s19, s16, 2560
    buffer_load_dwordx4 v4, s[8:11], s17 offen lds
    buffer_load_dwordx4 v4, s[8:11], s17 offen offset:1024 lds
    s_mov_b32 exec_hi, 0
    buffer_load_dwordx4 v4, s[8:11], s17 offen offset:2048 lds
    s_mov_b32 m0, s19
    s_mov_b64 exec, s[34:35]
    buffer_load_dwordx4 v10, s[8:11], s18 offen offset:2048 lds
    s_mov_b64 exec, s[28:29]
    buffer_load_dwordx4 v8, s[8:11], s18 offen lds
    s_mov_b64 exec, s[30:31]
    buffer_load_dwordx4 v9, s[8:11], s18 offen offset:1024 lds
    s_mov_b64 exec, -1
    s_add_u32 s16, s16, 20992
    s_add_u32 s17, s17, 10240
    s_add_u32 s18, s18, 328192
    s_mov_b32 m0, s16
    s_add_u32 s19, s16, 2560
    buffer_load_dwordx4 v4, s[8:11], s17 offen lds
    buffer_load_dwordx4 v4, s[8:11], s17 offen offset:1024 lds
    s_mov_b32 exec_hi, 0
    buffer_load_dwordx4 v4, s[8:11], s17 offen offset:2048 lds
    s_mov_b32 m0, s19
    s_mov_b64 exec, s[34:35]
    buffer_load_dwordx4 v10, s[8:11], s18 offen offset:2048 lds
    s_mov_b64 exec, s[28:29]
    buffer_load_dwordx4 v8, s[8:11], s18 offen lds
    s_mov_b64 exec, s[30:31]
    buffer_load_dwordx4 v9, s[8:11], s18 offen offset:1024 lds
    s_mov_b64 exec, -1
    s_add_u32 s16, s16, 20992
    s_add_u32 s17, s17, 10240
    s_add_u32 s18, s18, 328192
    s_mov_b32 m0, s16
    s_add_u32 s19, s16, 2560
    buffer_load_dwordx4 v4, s[8:11], s17 offen lds
    buffer_load_dwordx4 v4, s[8:11], s17 offen offset:1024 lds
    s_mov_b32 exec_hi, 0
    buffer_load_dwordx4 v4, s[8:11], s17 offen offset:2048 lds
    s_mov_b32 m0, s19
    s_mov_b64 exec, s[34:35]
    buffer_load_dwordx4 v10, s[8:11], s18 offen offset:2048 lds
    s_mov_b64 exec, s[28:29]
    buffer_load_dwordx4 v8, s[8:11], s18 offen lds
    s_mov_b64 exec, s[30:31]
    buffer_load_dwordx4 v9, s[8:11], s18 offen offset:1024 lds
    s_mov_b64 exec, -1
    s_add_u32 s16, s16, 20992
    s_add_u32 s17, s17, 10240
    s_add_u32 s18, s18, 328192
    s_mov_b32 m0, s16
    s_add_u32 s19, s16, 2560
    buffer_load_dwordx4 v4, s[8:11], s17 offen lds
    buffer_load_dwordx4 v4, s[8:11], s17 offen offset:1024 lds
    s_mov_b32 exec_hi, 0
    buffer_load_dwordx4 v4, s[8:11], s17 offen offset:2048 lds
    s_mov_b32 m0, s19
    s_mov_b64 exec, s[34:35]
    buffer_load_dwordx4 v10, s[8:11], s18 offen offset:2048 lds
    s_mov_b64 exec, s[28:29]
    buffer_load_dwordx4 v8, s[8:11], s18 offen lds
    s_mov_b64 exec, s[30:31]
    buffer_load_dwordx4 v9, s[8:11], s18 offen offset:1024 lds
    s_mov_b64 exec, -1
    s_add_u32 s16, s16, 20992
    s_add_u32 s17, s17, 10240
    s_add_u32 s18, s18, 328192
    s_mov_b32 m0, s16
    s_add_u32 s19, s16, 2560
    buffer_load_dwordx4 v4, s[8:11], s17 offen lds
    buffer_load_dwordx4 v4, s[8:11], s17 offen offset:1024 lds
    s_mov_b32 exec_hi, 0
    buffer_load_dwordx4 v4, s[8:11], s17 offen offset:2048 lds
    s_mov_b32 m0, s19
    s_mov_b64 exec, s[34:35]
    buffer_load_dwordx4 v10, s[8:11], s18 offen offset:2048 lds
    s_mov_b64 exec, s[28:29]
    buffer_load_dwordx4 v8, s[8:11], s18 offen lds
    s_mov_b64 exec, s[30:31]
    buffer_load_dwordx4 v9, s[8:11], s18 offen offset:1024 lds
    s_mov_b64 exec, -1
    s_add_u32 s16, s16, 20992
    s_add_u32 s17, s17, 10240
    s_add_u32 s18, s18, 328192
    s_mov_b32 m0, s16
    s_add_u32 s19, s16, 2560
    buffer_load_dwordx4 v4, s[8:11], s17 offen lds
    buffer_load_dwordx4 v4, s[8:11], s17 offen offset:1024 lds
    s_mov_b32 exec_hi, 0
    buffer_load_dwordx4 v4, s[8:11], s17 offen offset:2048 lds
    s_mov_b32 m0, s19
    s_mov_b64 exec, s[34:35]
    buffer_load_dwordx4 v10, s[8:11], s18 offen offset:2048 lds
    s_mov_b64 exec, s[28:29]
    buffer_load_dwordx4 v8, s[8:11], s18 offen lds
    s_mov_b64 exec, s[30:31]
    buffer_load_dwordx4 v9, s[8:11], s18 offen offset:1024 lds
    s_mov_b64 exec, -1
    s_add_u32 s16, s16, 20992
    s_add_u32 s17, s17, 10240
    s_add_u32 s18, s18, 328192
    s_cmp_eq_u32 s14, 3
    s_cbranch_scc1 K2_Ra
    s_mov_b32 m0, s16
    s_add_u32 s19, s16, 2560
    buffer_load_dwordx4 v4, s[8:11], s17 offen lds
    buffer_load_dwordx4 v4, s[8:11], s17 offen offset:1024 lds
    s_mov_b32 exec_hi, 0
    buffer_load_dwordx4 v4, s[8:11], s17 offen offset:2048 lds
    s_mov_b32 m0, s19
    s_mov_b64 exec, s[34:35]
    buffer_load_dwordx4 v10, s[8:11], s18 offen offset:2048 lds
    s_mov_b64 exec, s[28:29]
    buffer_load_dwordx4 v8, s[8:11], s18 offen lds
    s_mov_b64 exec, s[30:31]
    buffer_load_dwordx4 v9, s[8:11], s18 offen offset:1024 lds
    s_mov_b64 exec, -1
K2_Ra:
    s_waitcnt vmcnt(30)
    s_barrier
    s_waitcnt vmcnt(0)
    s_barrier
    v_lshrrev_b32 v3, 4, v1
    v_and_b32 v7, 15, v1
    s_lshr_b32 s39, s6, 2
    s_lshl_b32 s39, s39, 2
    s_add_u32 s39, s39, s14
    s_mul_i32 s39, s39, 81920
    s_add_u32 s39, s39, 7868416
    s_lshl_b32 s47, s3, 2
    s_and_b32 s50, s6, 3
    s_add_u32 s47, s47, s50
    s_lshl_b32 s47, s47, 8
    s_add_u32 s39, s39, s47
    s_add_u32 s50, s39, 65536
    s_add_u32 s39, s39, s47
    s_add_u32 s47, s39, 32768
    v_and_b32 v204, 1, v3
    v_lshrrev_b32 v205, 1, v3
    v_lshlrev_b32 v206, 4, v7
    v_lshl_add_u32 v208, v204, 14, v206
    v_lshl_add_u32 v208, v205, 8, v208
    v_lshl_add_u32 v209, v204, 13, v206
    v_lshl_or_b32 v209, v205, 31, v209
    v_mov_b32 v204, -1
    v_mov_b32 v205, -1
    v_mov_b32 v206, -1
    v_mov_b32 v207, -1
    buffer_store_dwordx4 v[204:207], v208, s[20:23], s39 offen sc1
    buffer_store_dwordx4 v[204:207], v208, s[20:23], s47 offen sc1
    buffer_store_dwordx4 v[204:207], v209, s[20:23], s50 offen sc1
    s_waitcnt vmcnt(0)
    s_barrier
    v_mov_b32 v196, 0x80000000
    s_branch K2_G
K2_LP:
    s_setprio 0
    s_sub_u32 s14, s26, 4
    s_mov_b32 s6, s10
    s_mov_b64 s[4:5], s[8:9]
    s_mov_b32 s10, 0xe4c400
    s_mov_b32 s11, 0x00020000
    s_lshl_b32 s12, s3, 2
    s_and_b32 s7, s6, 3
    s_add_u32 s12, s12, s7
    s_mul_i32 s15, s12, 81920
    s_mul_i32 s17, s14, 2560
    s_add_u32 s17, s17, s15
    s_add_u32 s17, s17, 2624000
    s_mul_i32 s16, s14, 5248
    s_mul_i32 s18, s14, 82048
    s_add_u32 s18, s18, 5322880
    v_lshlrev_b32 v4, 4, v1
    v_mov_b32 v191, 163776
    v_lshrrev_b32 v12, 3, v1
    v_mul_u32_u24 v12, 20992, v12
    v_and_b32 v13, 7, v1
    v_mul_u32_u24 v13, 336, v13
    s_add_u32 s19, s16, 2880
    v_add3_u32 v12, v12, v13, s19
    v_mov_b32 v200, 0x3f803f80
    v_mov_b32 v201, 0x3f803f80
    v_mov_b32 v202, 0x3f803f80
    v_mov_b32 v203, 0x3f803f80
    s_cmp_eq_u32 s14, 3
    s_cselect_b32 s36, 0x00ffffff, -1
    v_add_u32 v5, 0, v1
    v_mul_u32_u24 v6, 3121, v5
    v_lshrrev_b32 v6, 16, v6
    v_mul_u32_u24 v7, 21, v6
    v_sub_u32 v5, v5, v7
    s_and_b32 s46, s12, 1
    s_lshl_b32 s46, s46, 2
    s_mul_i32 s47, s12, 320
    v_and_b32 v8, 0x13, v5
    v_and_b32 v7, 4, v5
    v_lshl_add_u32 v8, v7, 1, v8
    v_bfe_u32 v7, v5, 3, 1
    v_lshl_add_u32 v8, v7, 2, v8
    v_add_u32 v8, s46, v8
    v_subrev_u32 v7, 20, v8
    v_min_u32 v8, v8, v7
    v_lshl_add_u32 v8, v8, 4, s47
    v_mul_u32_u24 v6, 10240, v6
    v_add_u32 v8, v8, v6
    v_cmp_ne_u32 s[28:29], 20, v5
    v_add_u32 v8, 2048, v8
    v_add_u32 v5, 64, v1
    v_mul_u32_u24 v6, 3121, v5
    v_lshrrev_b32 v6, 16, v6
    v_mul_u32_u24 v7, 21, v6
    v_sub_u32 v5, v5, v7
    v_and_b32 v9, 0x13, v5
    v_and_b32 v7, 4, v5
    v_lshl_add_u32 v9, v7, 1, v9
    v_bfe_u32 v7, v5, 3, 1
    v_lshl_add_u32 v9, v7, 2, v9
    v_add_u32 v9, s46, v9
    v_subrev_u32 v7, 20, v9
    v_min_u32 v9, v9, v7
    v_lshl_add_u32 v9, v9, 4, s47
    v_mul_u32_u24 v6, 10240, v6
    v_add_u32 v9, v9, v6
    v_cmp_ne_u32 s[30:31], 20, v5
    v_add_u32 v9, 1024, v9
    v_add_u32 v5, 128, v1
    v_mul_u32_u24 v6, 3121, v5
    v_lshrrev_b32 v6, 16, v6
    v_mul_u32_u24 v7, 21, v6
    v_sub_u32 v5, v5, v7
    v_and_b32 v10, 0x13, v5
    v_and_b32 v7, 4, v5
    v_lshl_add_u32 v10, v7, 1, v10
    v_bfe_u32 v7, v5, 3, 1
    v_lshl_add_u32 v10, v7, 2, v10
    v_add_u32 v10, s46, v10
    v_subrev_u32 v7, 20, v10
    v_min_u32 v10, v10, v7
    v_lshl_add_u32 v10, v10, 4, s47
    v_mul_u32_u24 v6, 10240, v6
    v_add_u32 v10, v10, v6
    v_cmp_ne_u32 s[34:35], 20, v5
    v_add_u32 v10, 0, v10
    s_nop 4
    s_and_b32 s35, s35, 0xff
    s_mov_b32 s52, 0x000f0011
    s_mov_b32 s53, 0
    s_mov_b32 s48, 262144
K2_F0:
    v_cmp_ne_u32 vcc, s33, v219
    s_and_b64 vcc, vcc, s[52:53]
    s_cbranch_vccz K2_F02
    s_sleep 4
    buffer_load_dword v219, v216, s[20:23], 0 offen sc1
    s_waitcnt vmcnt(0)
    s_sub_u32 s48, s48, 1
    s_cbranch_scc0 K2_F0
K2_F02:
    v_mov_b32 v220, s33
    ds_write_b32 v191, v220 offset:16
    s_mov_b32 s52, 13090
    s_mov_b32 s48, 262144
K2_F1:
    v_cmp_ne_u32 vcc, s33, v219
    s_and_b64 vcc, vcc, s[52:53]
    s_cbranch_vccz K2_F12
    s_sleep 4
    buffer_load_dword v219, v216, s[20:23], 0 offen sc1
    s_waitcnt vmcnt(0)
    s_sub_u32 s48, s48, 1
    s_cbranch_scc0 K2_F1
K2_F12:
    v_mov_b32 v220, s33
    ds_write_b32 v191, v220 offset:4
    s_mov_b32 m0, s16
    s_add_u32 s19, s16, 2560
    buffer_load_dwordx4 v4, s[8:11], s17 offen lds
    buffer_load_dwordx4 v4, s[8:11], s17 offen offset:1024 lds
    s_mov_b32 exec_hi, 0
    buffer_load_dwordx4 v4, s[8:11], s17 offen offset:2048 lds
    s_mov_b32 m0, s19
    s_mov_b64 exec, s[34:35]
    buffer_load_dwordx4 v10, s[8:11], s18 offen offset:2048 lds
    s_mov_b64 exec, s[28:29]
    buffer_load_dwordx4 v8, s[8:11], s18 offen lds
    s_mov_b64 exec, s[30:31]
    buffer_load_dwordx4 v9, s[8:11], s18 offen offset:1024 lds
    s_mov_b64 exec, -1
    s_add_u32 s16, s16, 20992
    s_add_u32 s17, s17, 10240
    s_add_u32 s18, s18, 328192
    s_mov_b64 exec, 0xff
    ds_write_b128 v12, v[200:203]
    s_mov_b64 exec, -1
    buffer_load_dword v219, v217, s[20:23], 0 offen sc1
    s_waitcnt vmcnt(0) lgkmcnt(0)
    s_barrier
    s_mov_b32 exec_lo, 0xffffff00
    s_mov_b32 exec_hi, s36
    ds_write_b128 v12, v[200:203]
    s_mov_b64 exec, -1
    s_mov_b32 s48, 262144
K2_F2:
    v_cmp_ne_u32 vcc, s33, v219
    s_cbranch_vccz K2_F22
    s_sleep 4
    buffer_load_dword v219, v217, s[20:23], 0 offen sc1
    s_waitcnt vmcnt(0)
    s_sub_u32 s48, s48, 1
    s_cbranch_scc0 K2_F2
K2_F22:
    v_mov_b32 v220, s33
    ds_write_b32 v191, v220 offset:8
    s_mov_b32 m0, s16
    s_add_u32 s19, s16, 2560
    buffer_load_dwordx4 v4, s[8:11], s17 offen lds
    buffer_load_dwordx4 v4, s[8:11], s17 offen offset:1024 lds
    s_mov_b32 exec_hi, 0
    buffer_load_dwordx4 v4, s[8:11], s17 offen offset:2048 lds
    s_mov_b32 m0, s19
    s_mov_b64 exec, s[34:35]
    buffer_load_dwordx4 v10, s[8:11], s18 offen offset:2048 lds
    s_mov_b64 exec, s[28:29]
    buffer_load_dwordx4 v8, s[8:11], s18 offen lds
    s_mov_b64 exec, s[30:31]
    buffer_load_dwordx4 v9, s[8:11], s18 offen offset:1024 lds
    s_mov_b64 exec, -1
    s_add_u32 s16, s16, 20992
    s_add_u32 s17, s17, 10240
    s_add_u32 s18, s18, 328192
    s_mov_b32 m0, s16
    s_add_u32 s19, s16, 2560
    buffer_load_dwordx4 v4, s[8:11], s17 offen lds
    buffer_load_dwordx4 v4, s[8:11], s17 offen offset:1024 lds
    s_mov_b32 exec_hi, 0
    buffer_load_dwordx4 v4, s[8:11], s17 offen offset:2048 lds
    s_mov_b32 m0, s19
    s_mov_b64 exec, s[34:35]
    buffer_load_dwordx4 v10, s[8:11], s18 offen offset:2048 lds
    s_mov_b64 exec, s[28:29]
    buffer_load_dwordx4 v8, s[8:11], s18 offen lds
    s_mov_b64 exec, s[30:31]
    buffer_load_dwordx4 v9, s[8:11], s18 offen offset:1024 lds
    s_mov_b64 exec, -1
    s_add_u32 s16, s16, 20992
    s_add_u32 s17, s17, 10240
    s_add_u32 s18, s18, 328192
    s_mov_b32 m0, s16
    s_add_u32 s19, s16, 2560
    buffer_load_dwordx4 v4, s[8:11], s17 offen lds
    buffer_load_dwordx4 v4, s[8:11], s17 offen offset:1024 lds
    s_mov_b32 exec_hi, 0
    buffer_load_dwordx4 v4, s[8:11], s17 offen offset:2048 lds
    s_mov_b32 m0, s19
    s_mov_b64 exec, s[34:35]
    buffer_load_dwordx4 v10, s[8:11], s18 offen offset:2048 lds
    s_mov_b64 exec, s[28:29]
    buffer_load_dwordx4 v8, s[8:11], s18 offen lds
    s_mov_b64 exec, s[30:31]
    buffer_load_dwordx4 v9, s[8:11], s18 offen offset:1024 lds
    s_mov_b64 exec, -1
    s_add_u32 s16, s16, 20992
    s_add_u32 s17, s17, 10240
    s_add_u32 s18, s18, 328192
    s_mov_b32 m0, s16
    s_add_u32 s19, s16, 2560
    buffer_load_dwordx4 v4, s[8:11], s17 offen lds
    buffer_load_dwordx4 v4, s[8:11], s17 offen offset:1024 lds
    s_mov_b32 exec_hi, 0
    buffer_load_dwordx4 v4, s[8:11], s17 offen offset:2048 lds
    s_mov_b32 m0, s19
    s_mov_b64 exec, s[34:35]
    buffer_load_dwordx4 v10, s[8:11], s18 offen offset:2048 lds
    s_mov_b64 exec, s[28:29]
    buffer_load_dwordx4 v8, s[8:11], s18 offen lds
    s_mov_b64 exec, s[30:31]
    buffer_load_dwordx4 v9, s[8:11], s18 offen offset:1024 lds
    s_mov_b64 exec, -1
    s_add_u32 s16, s16, 20992
    s_add_u32 s17, s17, 10240
    s_add_u32 s18, s18, 328192
    s_mov_b32 m0, s16
    s_add_u32 s19, s16, 2560
    buffer_load_dwordx4 v4, s[8:11], s17 offen lds
    buffer_load_dwordx4 v4, s[8:11], s17 offen offset:1024 lds
    s_mov_b32 exec_hi, 0
    buffer_load_dwordx4 v4, s[8:11], s17 offen offset:2048 lds
    s_mov_b32 m0, s19
    s_mov_b64 exec, s[34:35]
    buffer_load_dwordx4 v10, s[8:11], s18 offen offset:2048 lds
    s_mov_b64 exec, s[28:29]
    buffer_load_dwordx4 v8, s[8:11], s18 offen lds
    s_mov_b64 exec, s[30:31]
    buffer_load_dwordx4 v9, s[8:11], s18 offen offset:1024 lds
    s_mov_b64 exec, -1
    s_add_u32 s16, s16, 20992
    s_add_u32 s17, s17, 10240
    s_add_u32 s18, s18, 328192
    s_mov_b32 m0, s16
    s_add_u32 s19, s16, 2560
    buffer_load_dwordx4 v4, s[8:11], s17 offen lds
    buffer_load_dwordx4 v4, s[8:11], s17 offen offset:1024 lds
    s_mov_b32 exec_hi, 0
    buffer_load_dwordx4 v4, s[8:11], s17 offen offset:2048 lds
    s_mov_b32 m0, s19
    s_mov_b64 exec, s[34:35]
    buffer_load_dwordx4 v10, s[8:11], s18 offen offset:2048 lds
    s_mov_b64 exec, s[28:29]
    buffer_load_dwordx4 v8, s[8:11], s18 offen lds
    s_mov_b64 exec, s[30:31]
    buffer_load_dwordx4 v9, s[8:11], s18 offen offset:1024 lds
    s_mov_b64 exec, -1
    s_add_u32 s16, s16, 20992
    s_add_u32 s17, s17, 10240
    s_add_u32 s18, s18, 328192
    s_cmp_eq_u32 s14, 3
    s_cbranch_scc1 K2_Rb
    s_mov_b32 m0, s16
    s_add_u32 s19, s16, 2560
    buffer_load_dwordx4 v4, s[8:11], s17 offen lds
    buffer_load_dwordx4 v4, s[8:11], s17 offen offset:1024 lds
    s_mov_b32 exec_hi, 0
    buffer_load_dwordx4 v4, s[8:11], s17 offen offset:2048 lds
    s_mov_b32 m0, s19
    s_mov_b64 exec, s[34:35]
    buffer_load_dwordx4 v10, s[8:11], s18 offen offset:2048 lds
    s_mov_b64 exec, s[28:29]
    buffer_load_dwordx4 v8, s[8:11], s18 offen lds
    s_mov_b64 exec, s[30:31]
    buffer_load_dwordx4 v9, s[8:11], s18 offen offset:1024 lds
    s_mov_b64 exec, -1
K2_Rb:
    s_waitcnt vmcnt(30) lgkmcnt(0)
    s_barrier
    buffer_load_dword v219, v218, s[20:23], 0 offen sc1
    s_mov_b32 s52, 0
    s_mov_b32 s53, -1
    s_waitcnt vmcnt(0)
    s_mov_b32 s48, 262144
K2_F3:
    v_cmp_ne_u32 vcc, s33, v219
    s_and_b64 vcc, vcc, s[52:53]
    s_cbranch_vccz K2_F32
    s_sleep 4
    buffer_load_dword v219, v218, s[20:23], 0 offen sc1
    s_waitcnt vmcnt(0)
    s_sub_u32 s48, s48, 1
    s_cbranch_scc0 K2_F3
K2_F32:
    s_barrier
    v_lshrrev_b32 v3, 4, v1
    v_and_b32 v7, 15, v1
    s_lshr_b32 s39, s6, 2
    s_lshl_b32 s39, s39, 2
    s_add_u32 s39, s39, s14
    s_mul_i32 s39, s39, 81920
    s_add_u32 s39, s39, 7868416
    s_lshl_b32 s47, s3, 2
    s_and_b32 s50, s6, 3
    s_add_u32 s47, s47, s50
    s_lshl_b32 s47, s47, 8
    s_add_u32 s39, s39, s47
    s_add_u32 s50, s39, 65536
    s_add_u32 s39, s39, s47
    s_add_u32 s47, s39, 32768
    v_and_b32 v204, 1, v3
    v_lshrrev_b32 v205, 1, v3
    v_lshlrev_b32 v206, 4, v7
    v_lshl_add_u32 v208, v204, 14, v206
    v_lshl_add_u32 v208, v205, 8, v208
    v_lshl_add_u32 v209, v204, 13, v206
    v_lshl_or_b32 v209, v205, 31, v209
    v_mov_b32 v204, -1
    v_mov_b32 v205, -1
    v_mov_b32 v206, -1
    v_mov_b32 v207, -1
    buffer_store_dwordx4 v[204:207], v208, s[20:23], s39 offen sc1
    buffer_store_dwordx4 v[204:207], v208, s[20:23], s47 offen sc1
    buffer_store_dwordx4 v[204:207], v209, s[20:23], s50 offen sc1
    s_waitcnt vmcnt(0)
    s_barrier
    v_mov_b32 v196, v218
    s_lshl_b32 s39, s2, 7
    s_add_u32 s39, s39, 14587968
    s_mov_b64 exec, 1
    buffer_store_dword v220, off, s[20:23], s39 sc1
    s_mov_b64 exec, -1
K2_G:
    s_load_dwordx2 s[28:29], s[0:1], 0
    s_load_dwordx2 s[30:31], s[0:1], 32
    s_load_dwordx2 s[34:35], s[0:1], 64
    s_load_dwordx4 s[52:55], s[0:1], 40
    s_load_dwordx2 s[56:57], s[0:1], 56
    s_mov_b32 s25, 14018560
    s_load_dword s49, s[4:5], s25
    s_lshl_b32 s12, s3, 2
    s_lshr_b32 s7, s6, 3
    s_add_u32 s12, s12, s7
    s_and_b32 s13, s6, 7
    v_subrev_u32 v1, 256, v0
    s_waitcnt lgkmcnt(0)
    s_mul_i32 s16, s13, 102400
    s_mul_i32 s17, s14, 25600
    s_add_u32 s16, s16, s17
    s_add_u32 s16, s16, 13144064
    s_add_u32 s17, s16, 0
    buffer_load_dwordx4 v[16:19], v4, s[8:11], s17 offen offset:0
    buffer_load_dwordx4 v[20:23], v4, s[8:11], s17 offen offset:1024
    buffer_load_dwordx4 v[24:27], v4, s[8:11], s17 offen offset:2048
    buffer_load_dwordx4 v[28:31], v4, s[8:11], s17 offen offset:3072
    s_add_u32 s17, s16, 4096
    buffer_load_dwordx4 v[32:35], v4, s[8:11], s17 offen offset:0
    buffer_load_dwordx4 v[36:39], v4, s[8:11], s17 offen offset:1024
    buffer_load_dwordx4 v[40:43], v4, s[8:11], s17 offen offset:2048
    buffer_load_dwordx4 v[44:47], v4, s[8:11], s17 offen offset:3072
    s_add_u32 s17, s16, 8192
    buffer_load_dwordx4 v[48:51], v4, s[8:11], s17 offen offset:0
    buffer_load_dwordx4 v[52:55], v4, s[8:11], s17 offen offset:1024
    buffer_load_dwordx4 v[56:59], v4, s[8:11], s17 offen offset:2048
    buffer_load_dwordx4 v[60:63], v4, s[8:11], s17 offen offset:3072
    s_add_u32 s17, s16, 12288
    buffer_load_dwordx4 v[64:67], v4, s[8:11], s17 offen offset:0
    buffer_load_dwordx4 v[68:71], v4, s[8:11], s17 offen offset:1024
    buffer_load_dwordx4 v[72:75], v4, s[8:11], s17 offen offset:2048
    buffer_load_dwordx4 v[76:79], v4, s[8:11], s17 offen offset:3072
    s_add_u32 s17, s16, 16384
    buffer_load_dwordx4 v[80:83], v4, s[8:11], s17 offen offset:0
    buffer_load_dwordx4 v[84:87], v4, s[8:11], s17 offen offset:1024
    buffer_load_dwordx4 v[88:91], v4, s[8:11], s17 offen offset:2048
    buffer_load_dwordx4 v[92:95], v4, s[8:11], s17 offen offset:3072
    s_add_u32 s17, s16, 20480
    buffer_load_dwordx4 v[96:99], v4, s[8:11], s17 offen offset:0
    buffer_load_dwordx4 v[100:103], v4, s[8:11], s17 offen offset:1024
    buffer_load_dwordx4 v[104:107], v4, s[8:11], s17 offen offset:2048
    buffer_load_dwordx4 v[108:111], v4, s[8:11], s17 offen offset:3072
    s_add_u32 s17, s16, 24576
    buffer_load_dwordx4 v[112:115], v4, s[8:11], s17 offen offset:0
    s_mov_b32 s20, s28
    s_mov_b32 s21, s29
    s_mov_b32 s22, 0x280000
    s_mov_b32 s23, 0x00020000
    s_mov_b32 s24, s30
    s_mov_b32 s25, s31
    s_mov_b32 s26, 0x500
    s_mov_b32 s27, 0x00020000
    s_mov_b32 s40, s34
    s_mov_b32 s41, s35
    s_mov_b32 s42, 0x280000
    s_mov_b32 s43, 0x00020000
    v_and_b32 v5, 15, v0
    v_bfe_u32 v6, v0, 4, 2
    v_mul_u32_u24 v7, 40, v6
    s_mul_i32 s17, s13, 160
    v_add_u32 v7, s17, v7
    v_mul_u32_u24 v8, 1280, v5
    v_add_u32 v8, v8, v7
    s_lshl_b32 s15, s12, 2
    s_add_u32 s15, s15, s14
    s_mul_i32 s18, s15, 20480
    buffer_load_dwordx4 v[236:239], v8, s[20:23], s18 offen
    buffer_load_dwordx4 v[240:243], v8, s[20:23], s18 offen offset:16
    buffer_load_dwordx2 v[244:245], v8, s[20:23], s18 offen offset:32
    buffer_load_dwordx4 v[246:249], v7, s[24:27], 0 offen
    buffer_load_dwordx4 v[250:253], v7, s[24:27], 0 offen offset:16
    buffer_load_dwordx2 v[254:255], v7, s[24:27], 0 offen offset:32
    v_lshlrev_b32 v9, 4, v5
    v_lshl_add_u32 v9, v6, 9, v9
    s_mul_i32 s16, s12, 81920
    s_add_u32 s16, s16, 7868416
    s_lshl_b32 s17, s14, 11
    s_add_u32 s16, s16, s17
    s_and_b32 s19, s14, 1
    s_lshl_b32 s19, s19, 13
    s_add_u32 s20, s16, 65536
    s_add_u32 s21, s20, 8192
    s_add_u32 s20, s20, s19
    s_sub_u32 s21, s21, s19
    s_add_u32 s16, s16, s17
    s_xor_b32 s17, s14, 0
    s_lshl_b32 s19, s17, 14
    s_add_u32 s44, s16, s19
    s_mul_i32 s17, s17, 5120
    v_add_u32 v14, s17, v4
    s_xor_b32 s17, s14, 1
    s_lshl_b32 s19, s17, 14
    s_add_u32 s45, s16, s19
    s_mul_i32 s17, s17, 5120
    v_add_u32 v11, s17, v4
    s_xor_b32 s17, s14, 2
    s_lshl_b32 s19, s17, 14
    s_add_u32 s46, s16, s19
    s_mul_i32 s17, s17, 5120
    v_add_u32 v12, s17, v4
    s_xor_b32 s17, s14, 3
    s_lshl_b32 s19, s17, 14
    s_add_u32 s47, s16, s19
    s_mul_i32 s17, s17, 5120
    v_add_u32 v13, s17, v4
    s_lshl_b32 s29, s12, 13
    s_lshl_b32 s17, s14, 8
    s_add_u32 s29, s29, s17
    s_add_u32 s29, s29, 14321664
    s_lshl_b32 s17, s13, 10
    s_add_u32 s28, s29, s17
    v_lshlrev_b32 v15, 4, v5
    v_lshl_or_b32 v10, v6, 30, v15
    v_lshl_add_u32 v15, v6, 10, v15
    s_mul_i32 s30, s12, 2560
    s_mul_i32 s17, s13, 320
    s_add_u32 s30, s30, s17
    s_add_u32 s30, s30, 14620672
    s_lshl_b32 s31, s12, 7
    s_add_u32 s31, s31, 14583808
    s_min_u32 s59, s13, 1
    s_lshl_b32 s59, s59, 29
    s_lshl_b32 s32, s15, 4
    s_mov_b32 s19, 0x3f803f80
    v_lshrrev_b32 v2, 1, v1
    s_cmp_ge_u32 s6, 27
    s_cbranch_scc1 KT_GC
    s_mov_b32 s36, s52
    s_mov_b32 s37, s53
    s_mov_b32 s38, 0x21c000
    s_mov_b32 s39, 0x00020000
    s_mov_b32 s52, s54
    s_mov_b32 s53, s55
    s_mov_b32 s54, 0x21c000
    s_mov_b32 s55, 0x00020000
    s_mul_i32 s16, s3, 27
    s_add_u32 s16, s16, s6
    s_lshl_b32 s16, s16, 4
    v_mul_u32_u24 v2, 17280, v2
    v_add_u32 v2, s16, v2
    s_mov_b32 s56, 0x55555555
    s_mov_b32 s57, s56
    s_mov_b32 s16, 0
    s_mov_b64 exec, s[56:57]
    buffer_load_dwordx4 v[116:119], v2, s[36:39], s16 offen
    s_not_b64 exec, s[56:57]
    buffer_load_dwordx4 v[116:119], v2, s[52:55], s16 offen
    s_mov_b32 s16, 3456
    s_mov_b64 exec, s[56:57]
    buffer_load_dwordx4 v[120:123], v2, s[36:39], s16 offen
    s_not_b64 exec, s[56:57]
    buffer_load_dwordx4 v[120:123], v2, s[52:55], s16 offen
    s_mov_b32 s16, 6912
    s_mov_b64 exec, s[56:57]
    buffer_load_dwordx4 v[124:127], v2, s[36:39], s16 offen
    s_not_b64 exec, s[56:57]
    buffer_load_dwordx4 v[124:127], v2, s[52:55], s16 offen
    s_mov_b32 s16, 10368
    s_mov_b64 exec, s[56:57]
    buffer_load_dwordx4 v[128:131], v2, s[36:39], s16 offen
    s_not_b64 exec, s[56:57]
    buffer_load_dwordx4 v[128:131], v2, s[52:55], s16 offen
    s_mov_b32 s16, 13824
    s_mov_b64 exec, s[56:57]
    buffer_load_dwordx4 v[132:135], v2, s[36:39], s16 offen
    s_not_b64 exec, s[56:57]
    buffer_load_dwordx4 v[132:135], v2, s[52:55], s16 offen
    s_mov_b64 exec, -1
    s_branch KT_GD
KT_GC:
    s_mov_b32 s36, s56
    s_mov_b32 s37, s57
    s_mov_b32 s38, 0x21c000
    s_mov_b32 s39, 0x00020000
    s_mul_i32 s16, s3, 5
    s_add_u32 s16, s16, s6
    s_sub_u32 s16, s16, 27
    s_lshl_b32 s16, s16, 5
    v_mul_u32_u24 v2, 20480, v2
    v_and_b32 v3, 1, v1
    v_lshl_add_u32 v2, v3, 4, v2
    v_add_u32 v2, s16, v2
    s_mov_b32 s16, 0
    buffer_load_dwordx4 v[116:119], v2, s[36:39], s16 offen
    s_mov_b32 s16, 1280
    buffer_load_dwordx4 v[120:123], v2, s[36:39], s16 offen
    s_mov_b32 s16, 2560
    buffer_load_dwordx4 v[124:127], v2, s[36:39], s16 offen
    s_mov_b32 s16, 3840
    buffer_load_dwordx4 v[128:131], v2, s[36:39], s16 offen
    s_mov_b32 s16, 5120
    buffer_load_dwordx4 v[132:135], v2, s[36:39], s16 offen
    s_mov_b32 s16, 6400
    buffer_load_dwordx4 v[136:139], v2, s[36:39], s16 offen
    s_mov_b32 s16, 7680
    buffer_load_dwordx4 v[140:143], v2, s[36:39], s16 offen
    s_mov_b32 s16, 8960
    buffer_load_dwordx4 v[144:147], v2, s[36:39], s16 offen
    s_mov_b32 s16, 10240
    buffer_load_dwordx4 v[148:151], v2, s[36:39], s16 offen
    s_mov_b32 s16, 11520
    buffer_load_dwordx4 v[152:155], v2, s[36:39], s16 offen
    s_mov_b32 s16, 12800
    buffer_load_dwordx4 v[156:159], v2, s[36:39], s16 offen
    s_mov_b32 s16, 14080
    buffer_load_dwordx4 v[160:163], v2, s[36:39], s16 offen
    s_mov_b32 s16, 15360
    buffer_load_dwordx4 v[164:167], v2, s[36:39], s16 offen
    s_mov_b32 s16, 16640
    buffer_load_dwordx4 v[168:171], v2, s[36:39], s16 offen
    s_mov_b32 s16, 17920
    buffer_load_dwordx4 v[172:175], v2, s[36:39], s16 offen
    s_mov_b32 s16, 19200
    buffer_load_dwordx4 v[176:179], v2, s[36:39], s16 offen
KT_GD:
    v_lshlrev_b32 v1, 4, v1
    v_add_u32 v1, 65536, v1
    s_cmp_lg_u32 s14, 2
    s_cbranch_scc1 K2_F42
    s_mov_b32 s48, 262144
K2_F4:
    buffer_load_dword v197, v196, s[8:11], 0 offen sc1
    s_waitcnt vmcnt(0)
    v_cmp_ne_u32 vcc, s33, v197
    s_cbranch_vccz K2_F42
    s_sleep 8
    s_sub_u32 s48, s48, 1
    s_cbranch_scc0 K2_F4
K2_F42:
    s_waitcnt vmcnt(0)
    s_setprio 3
    s_barrier
KT_A0:
    ds_write_b128 v1, v[116:119] offset:0
    ds_write_b128 v1, v[120:123] offset:4096
    ds_write_b128 v1, v[124:127] offset:8192
    ds_write_b128 v1, v[128:131] offset:12288
    ds_write_b128 v1, v[132:135] offset:16384
    s_cmp_lt_u32 s6, 27
    s_cbranch_scc1 KT_GH
    ds_write_b128 v1, v[136:139] offset:20480
    ds_write_b128 v1, v[140:143] offset:24576
    ds_write_b128 v1, v[144:147] offset:28672
    ds_write_b128 v1, v[148:151] offset:32768
    ds_write_b128 v1, v[152:155] offset:36864
    ds_write_b128 v1, v[156:159] offset:40960
    ds_write_b128 v1, v[160:163] offset:45056
    ds_write_b128 v1, v[164:167] offset:49152
    ds_write_b128 v1, v[168:171] offset:53248
    ds_write_b128 v1, v[172:175] offset:57344
    ds_write_b128 v1, v[176:179] offset:61440
KT_GH:
    s_waitcnt lgkmcnt(0)
    buffer_load_dwordx4 v[132:135], v9, s[8:11], s20 offen offset:0 sc1
    buffer_load_dwordx4 v[152:155], v9, s[8:11], s21 offen offset:0 sc1
    buffer_load_dwordx4 v[172:175], v9, s[8:11], s20 offen offset:256 sc1
    buffer_load_dwordx4 v[192:195], v9, s[8:11], s21 offen offset:256 sc1
    buffer_load_dwordx4 v[156:159], v4, s[8:11], s46 offen offset:0 sc1
    buffer_load_dwordx4 v[160:163], v4, s[8:11], s46 offen offset:1024 sc1
    buffer_load_dwordx4 v[164:167], v4, s[8:11], s46 offen offset:2048 sc1
    buffer_load_dwordx4 v[168:171], v4, s[8:11], s46 offen offset:3072 sc1
    buffer_load_dwordx4 v[176:179], v4, s[8:11], s47 offen offset:0 sc1
    buffer_load_dwordx4 v[180:183], v4, s[8:11], s47 offen offset:1024 sc1
    buffer_load_dwordx4 v[184:187], v4, s[8:11], s47 offen offset:2048 sc1
    buffer_load_dwordx4 v[188:191], v4, s[8:11], s47 offen offset:3072 sc1
    buffer_load_dwordx4 v[136:139], v4, s[8:11], s45 offen offset:0 sc1
    buffer_load_dwordx4 v[140:143], v4, s[8:11], s45 offen offset:1024 sc1
    buffer_load_dwordx4 v[144:147], v4, s[8:11], s45 offen offset:2048 sc1
    buffer_load_dwordx4 v[148:151], v4, s[8:11], s45 offen offset:3072 sc1
    buffer_load_dwordx4 v[116:119], v4, s[8:11], s44 offen offset:0 sc1
    buffer_load_dwordx4 v[120:123], v4, s[8:11], s44 offen offset:1024 sc1
    buffer_load_dwordx4 v[124:127], v4, s[8:11], s44 offen offset:2048 sc1
    buffer_load_dwordx4 v[128:131], v4, s[8:11], s44 offen offset:3072 sc1
    s_mov_b32 s48, 262144
    s_branch KT_O1
KT_O0:
    v_cmp_eq_u32 s[84:85], -1, v132
    v_cmp_eq_u32 s[86:87], -1, v152
    v_cmp_eq_u32 s[88:89], -1, v172
    v_cmp_eq_u32 s[90:91], -1, v192
    v_cmp_eq_u32 s[92:93], -1, v156
    v_cmp_eq_u32 s[94:95], -1, v160
    v_cmp_eq_u32 s[96:97], -1, v164
    v_cmp_eq_u32 s[98:99], -1, v168
    s_mov_b64 exec, s[84:85]
    buffer_load_dwordx4 v[132:135], v9, s[8:11], s20 offen offset:0 sc1
    s_mov_b64 exec, s[86:87]
    buffer_load_dwordx4 v[152:155], v9, s[8:11], s21 offen offset:0 sc1
    s_mov_b64 exec, s[88:89]
    buffer_load_dwordx4 v[172:175], v9, s[8:11], s20 offen offset:256 sc1
    s_mov_b64 exec, s[90:91]
    buffer_load_dwordx4 v[192:195], v9, s[8:11], s21 offen offset:256 sc1
    s_mov_b64 exec, s[92:93]
    buffer_load_dwordx4 v[156:159], v4, s[8:11], s46 offen offset:0 sc1
    s_mov_b64 exec, s[94:95]
    buffer_load_dwordx4 v[160:163], v4, s[8:11], s46 offen offset:1024 sc1
    s_mov_b64 exec, s[96:97]
    buffer_load_dwordx4 v[164:167], v4, s[8:11], s46 offen offset:2048 sc1
    s_mov_b64 exec, s[98:99]
    buffer_load_dwordx4 v[168:171], v4, s[8:11], s46 offen offset:3072 sc1
    s_mov_b64 exec, -1
    v_cmp_eq_u32 s[84:85], -1, v176
    v_cmp_eq_u32 s[86:87], -1, v180
    v_cmp_eq_u32 s[88:89], -1, v184
    v_cmp_eq_u32 s[90:91], -1, v188
    v_cmp_eq_u32 s[92:93], -1, v136
    v_cmp_eq_u32 s[94:95], -1, v140
    v_cmp_eq_u32 s[96:97], -1, v144
    v_cmp_eq_u32 s[98:99], -1, v148
    s_mov_b64 exec, s[84:85]
    buffer_load_dwordx4 v[176:179], v4, s[8:11], s47 offen offset:0 sc1
    s_mov_b64 exec, s[86:87]
    buffer_load_dwordx4 v[180:183], v4, s[8:11], s47 offen offset:1024 sc1
    s_mov_b64 exec, s[88:89]
    buffer_load_dwordx4 v[184:187], v4, s[8:11], s47 offen offset:2048 sc1
    s_mov_b64 exec, s[90:91]
    buffer_load_dwordx4 v[188:191], v4, s[8:11], s47 offen offset:3072 sc1
    s_mov_b64 exec, s[92:93]
    buffer_load_dwordx4 v[136:139], v4, s[8:11], s45 offen offset:0 sc1
    s_mov_b64 exec, s[94:95]
    buffer_load_dwordx4 v[140:143], v4, s[8:11], s45 offen offset:1024 sc1
    s_mov_b64 exec, s[96:97]
    buffer_load_dwordx4 v[144:147], v4, s[8:11], s45 offen offset:2048 sc1
    s_mov_b64 exec, s[98:99]
    buffer_load_dwordx4 v[148:151], v4, s[8:11], s45 offen offset:3072 sc1
    s_mov_b64 exec, -1
    v_cmp_eq_u32 s[84:85], -1, v116
    v_cmp_eq_u32 s[86:87], -1, v120
    v_cmp_eq_u32 s[88:89], -1, v124
    v_cmp_eq_u32 s[90:91], -1, v128
    s_mov_b64 exec, s[84:85]
    buffer_load_dwordx4 v[116:119], v4, s[8:11], s44 offen offset:0 sc1
    s_mov_b64 exec, s[86:87]
    buffer_load_dwordx4 v[120:123], v4, s[8:11], s44 offen offset:1024 sc1
    s_mov_b64 exec, s[88:89]
    buffer_load_dwordx4 v[124:127], v4, s[8:11], s44 offen offset:2048 sc1
    s_mov_b64 exec, s[90:91]
    buffer_load_dwordx4 v[128:131], v4, s[8:11], s44 offen offset:3072 sc1
    s_mov_b64 exec, -1
KT_O1:
    s_waitcnt vmcnt(17)
    v_max3_u32 v2, v132, v152, v172
    s_waitcnt vmcnt(15)
    v_max3_u32 v2, v2, v192, v156
    s_waitcnt vmcnt(13)
    v_max3_u32 v2, v2, v160, v164
    s_waitcnt vmcnt(11)
    v_max3_u32 v2, v2, v168, v176
    s_waitcnt vmcnt(9)
    v_max3_u32 v2, v2, v180, v184
    s_waitcnt vmcnt(7)
    v_max3_u32 v2, v2, v188, v136
    s_waitcnt vmcnt(5)
    v_max3_u32 v2, v2, v140, v144
    s_waitcnt vmcnt(3)
    v_max3_u32 v2, v2, v148, v116
    s_waitcnt vmcnt(1)
    v_max3_u32 v2, v2, v120, v124
    s_waitcnt vmcnt(0)
    v_max_u32 v2, v2, v128
    v_cmp_eq_u32 vcc, -1, v2
    s_cbranch_vccz KT_O2
    s_sub_u32 s48, s48, 1
    s_cbranch_scc0 KT_O0
KT_O2:
    v_swap_b32 v134, v172
    v_swap_b32 v135, v173
    v_swap_b32 v154, v192
    v_swap_b32 v155, v193
    v_mfma_f32_16x16x32_bf16 v[196:199], v[16:19], v[156:159], 0
    v_mfma_f32_16x16x32_bf16 v[200:203], v[20:23], v[156:159], 0
    v_mfma_f32_16x16x32_bf16 v[204:207], v[24:27], v[156:159], 0
    v_mfma_f32_16x16x32_bf16 v[208:211], v[28:31], v[156:159], 0
    v_mfma_f32_16x16x32_bf16 v[212:215], v[32:35], v[156:159], 0
    v_mfma_f32_16x16x32_bf16 v[196:199], v[36:39], v[160:163], v[196:199]
    v_mfma_f32_16x16x32_bf16 v[200:203], v[40:43], v[160:163], v[200:203]
    v_mfma_f32_16x16x32_bf16 v[204:207], v[44:47], v[160:163], v[204:207]
    v_mfma_f32_16x16x32_bf16 v[208:211], v[48:51], v[160:163], v[208:211]
    v_mfma_f32_16x16x32_bf16 v[212:215], v[52:55], v[160:163], v[212:215]
    v_mfma_f32_16x16x32_bf16 v[196:199], v[56:59], v[164:167], v[196:199]
    v_mfma_f32_16x16x32_bf16 v[200:203], v[60:63], v[164:167], v[200:203]
    v_mfma_f32_16x16x32_bf16 v[204:207], v[64:67], v[164:167], v[204:207]
    v_mfma_f32_16x16x32_bf16 v[208:211], v[68:71], v[164:167], v[208:211]
    v_mfma_f32_16x16x32_bf16 v[212:215], v[72:75], v[164:167], v[212:215]
    v_mfma_f32_16x16x32_bf16 v[196:199], v[76:79], v[168:171], v[196:199]
    v_mfma_f32_16x16x32_bf16 v[200:203], v[80:83], v[168:171], v[200:203]
    v_mfma_f32_16x16x32_bf16 v[204:207], v[84:87], v[168:171], v[204:207]
    v_mfma_f32_16x16x32_bf16 v[208:211], v[88:91], v[168:171], v[208:211]
    v_mfma_f32_16x16x32_bf16 v[212:215], v[92:95], v[168:171], v[212:215]
    v_mfma_f32_16x16x32_bf16 v[196:199], v[96:99], v[172:175], v[196:199]
    v_mfma_f32_16x16x32_bf16 v[200:203], v[100:103], v[172:175], v[200:203]
    v_mfma_f32_16x16x32_bf16 v[204:207], v[104:107], v[172:175], v[204:207]
    v_mfma_f32_16x16x32_bf16 v[208:211], v[108:111], v[172:175], v[208:211]
    v_mfma_f32_16x16x32_bf16 v[212:215], v[112:115], v[172:175], v[212:215]
    v_mfma_f32_16x16x32_bf16 v[216:219], v[16:19], v[176:179], 0
    v_mfma_f32_16x16x32_bf16 v[220:223], v[20:23], v[176:179], 0
    v_mfma_f32_16x16x32_bf16 v[224:227], v[24:27], v[176:179], 0
    v_mfma_f32_16x16x32_bf16 v[228:231], v[28:31], v[176:179], 0
    ds_write_b128 v12, v[196:199] offset:0
    v_mfma_f32_16x16x32_bf16 v[232:235], v[32:35], v[176:179], 0
    v_mfma_f32_16x16x32_bf16 v[216:219], v[36:39], v[180:183], v[216:219]
    ds_write_b128 v12, v[200:203] offset:1024
    v_mfma_f32_16x16x32_bf16 v[220:223], v[40:43], v[180:183], v[220:223]
    v_mfma_f32_16x16x32_bf16 v[224:227], v[44:47], v[180:183], v[224:227]
    ds_write_b128 v12, v[204:207] offset:2048
    v_mfma_f32_16x16x32_bf16 v[228:231], v[48:51], v[180:183], v[228:231]
    v_mfma_f32_16x16x32_bf16 v[232:235], v[52:55], v[180:183], v[232:235]
    ds_write_b128 v12, v[208:211] offset:3072
    v_mfma_f32_16x16x32_bf16 v[216:219], v[56:59], v[184:187], v[216:219]
    v_mfma_f32_16x16x32_bf16 v[220:223], v[60:63], v[184:187], v[220:223]
    ds_write_b128 v12, v[212:215] offset:4096
    v_mfma_f32_16x16x32_bf16 v[224:227], v[64:67], v[184:187], v[224:227]
    v_lshlrev_b32 v156, 16, v236
    v_and_b32 v157, 0xffff0000, v236
    v_mfma_f32_16x16x32_bf16 v[228:231], v[68:71], v[184:187], v[228:231]
    v_lshlrev_b32 v158, 16, v237
    v_and_b32 v159, 0xffff0000, v237
    v_mfma_f32_16x16x32_bf16 v[232:235], v[72:75], v[184:187], v[232:235]
    v_lshlrev_b32 v160, 16, v238
    v_and_b32 v161, 0xffff0000, v238
    v_mfma_f32_16x16x32_bf16 v[216:219], v[76:79], v[188:191], v[216:219]
    v_lshlrev_b32 v162, 16, v239
    v_and_b32 v163, 0xffff0000, v239
    v_mfma_f32_16x16x32_bf16 v[220:223], v[80:83], v[188:191], v[220:223]
    v_lshlrev_b32 v164, 16, v240
    v_and_b32 v165, 0xffff0000, v240
    v_mfma_f32_16x16x32_bf16 v[224:227], v[84:87], v[188:191], v[224:227]
    v_lshlrev_b32 v166, 16, v241
    v_and_b32 v167, 0xffff0000, v241
    v_mfma_f32_16x16x32_bf16 v[228:231], v[88:91], v[188:191], v[228:231]
    v_lshlrev_b32 v168, 16, v242
    v_and_b32 v169, 0xffff0000, v242
    v_mfma_f32_16x16x32_bf16 v[232:235], v[92:95], v[188:191], v[232:235]
    v_lshlrev_b32 v170, 16, v243
    v_and_b32 v171, 0xffff0000, v243
    v_mfma_f32_16x16x32_bf16 v[216:219], v[96:99], v[192:195], v[216:219]
    v_lshlrev_b32 v172, 16, v244
    v_and_b32 v173, 0xffff0000, v244
    v_mfma_f32_16x16x32_bf16 v[220:223], v[100:103], v[192:195], v[220:223]
    v_lshlrev_b32 v174, 16, v245
    v_and_b32 v175, 0xffff0000, v245
    v_mfma_f32_16x16x32_bf16 v[224:227], v[104:107], v[192:195], v[224:227]
    v_mfma_f32_16x16x32_bf16 v[228:231], v[108:111], v[192:195], v[228:231]
    v_mfma_f32_16x16x32_bf16 v[232:235], v[112:115], v[192:195], v[232:235]
    v_mfma_f32_16x16x32_bf16 v[196:199], v[16:19], v[136:139], 0
    v_mfma_f32_16x16x32_bf16 v[200:203], v[20:23], v[136:139], 0
    v_mfma_f32_16x16x32_bf16 v[204:207], v[24:27], v[136:139], 0
    v_mfma_f32_16x16x32_bf16 v[208:211], v[28:31], v[136:139], 0
    ds_write_b128 v13, v[216:219] offset:20480
    v_mfma_f32_16x16x32_bf16 v[212:215], v[32:35], v[136:139], 0
    v_mfma_f32_16x16x32_bf16 v[196:199], v[36:39], v[140:143], v[196:199]
    ds_write_b128 v13, v[220:223] offset:21504
    v_mfma_f32_16x16x32_bf16 v[200:203], v[40:43], v[140:143], v[200:203]
    v_mfma_f32_16x16x32_bf16 v[204:207], v[44:47], v[140:143], v[204:207]
    ds_write_b128 v13, v[224:227] offset:22528
    v_mfma_f32_16x16x32_bf16 v[208:211], v[48:51], v[140:143], v[208:211]
    v_mfma_f32_16x16x32_bf16 v[212:215], v[52:55], v[140:143], v[212:215]
    ds_write_b128 v13, v[228:231] offset:23552
    v_mfma_f32_16x16x32_bf16 v[196:199], v[56:59], v[144:147], v[196:199]
    v_mfma_f32_16x16x32_bf16 v[200:203], v[60:63], v[144:147], v[200:203]
    ds_write_b128 v13, v[232:235] offset:24576
    v_mfma_f32_16x16x32_bf16 v[204:207], v[64:67], v[144:147], v[204:207]
    v_mfma_f32_16x16x32_bf16 v[208:211], v[68:71], v[144:147], v[208:211]
    v_mfma_f32_16x16x32_bf16 v[212:215], v[72:75], v[144:147], v[212:215]
    v_mfma_f32_16x16x32_bf16 v[196:199], v[76:79], v[148:151], v[196:199]
    v_mfma_f32_16x16x32_bf16 v[200:203], v[80:83], v[148:151], v[200:203]
    v_mfma_f32_16x16x32_bf16 v[204:207], v[84:87], v[148:151], v[204:207]
    s_waitcnt lgkmcnt(0)
    s_barrier
    ds_read_b128 v[216:219], v14 offset:0
    v_mfma_f32_16x16x32_bf16 v[208:211], v[88:91], v[148:151], v[208:211]
    ds_read_b128 v[220:223], v14 offset:1024
    v_mfma_f32_16x16x32_bf16 v[212:215], v[92:95], v[148:151], v[212:215]
    ds_read_b128 v[224:227], v14 offset:2048
    v_mfma_f32_16x16x32_bf16 v[196:199], v[96:99], v[152:155], v[196:199]
    ds_read_b128 v[228:231], v14 offset:3072
    v_mfma_f32_16x16x32_bf16 v[200:203], v[100:103], v[152:155], v[200:203]
    ds_read_b128 v[232:235], v14 offset:4096
    v_mfma_f32_16x16x32_bf16 v[204:207], v[104:107], v[152:155], v[204:207]
    ds_read_b128 v[176:179], v11 offset:20480
    v_mfma_f32_16x16x32_bf16 v[208:211], v[108:111], v[152:155], v[208:211]
    ds_read_b128 v[180:183], v11 offset:21504
    v_mfma_f32_16x16x32_bf16 v[212:215], v[112:115], v[152:155], v[212:215]
    ds_read_b128 v[184:187], v11 offset:22528
    s_waitcnt lgkmcnt(3)
    v_mfma_f32_16x16x32_bf16 v[216:219], v[16:19], v[116:119], v[216:219]
    ds_read_b128 v[188:191], v11 offset:23552
    v_mfma_f32_16x16x32_bf16 v[220:223], v[20:23], v[116:119], v[220:223]
    ds_read_b128 v[192:195], v11 offset:24576
    v_mfma_f32_16x16x32_bf16 v[224:227], v[24:27], v[116:119], v[224:227]
    v_mfma_f32_16x16x32_bf16 v[228:231], v[28:31], v[116:119], v[228:231]
    s_waitcnt lgkmcnt(4)
    v_add_f32 v196, v196, v176
    v_add_f32 v197, v197, v177
    v_mfma_f32_16x16x32_bf16 v[232:235], v[32:35], v[116:119], v[232:235]
    v_add_f32 v198, v198, v178
    v_add_f32 v199, v199, v179
    v_mfma_f32_16x16x32_bf16 v[216:219], v[36:39], v[120:123], v[216:219]
    ds_write_b128 v11, v[196:199] offset:40960
    s_waitcnt lgkmcnt(3)
    v_add_f32 v200, v200, v180
    v_add_f32 v201, v201, v181
    v_mfma_f32_16x16x32_bf16 v[220:223], v[40:43], v[120:123], v[220:223]
    v_add_f32 v202, v202, v182
    v_add_f32 v203, v203, v183
    v_mfma_f32_16x16x32_bf16 v[224:227], v[44:47], v[120:123], v[224:227]
    ds_write_b128 v11, v[200:203] offset:41984
    s_waitcnt lgkmcnt(3)
    v_add_f32 v204, v204, v184
    v_add_f32 v205, v205, v185
    v_mfma_f32_16x16x32_bf16 v[228:231], v[48:51], v[120:123], v[228:231]
    v_add_f32 v206, v206, v186
    v_add_f32 v207, v207, v187
    v_mfma_f32_16x16x32_bf16 v[232:235], v[52:55], v[120:123], v[232:235]
    ds_write_b128 v11, v[204:207] offset:43008
    s_waitcnt lgkmcnt(3)
    v_add_f32 v208, v208, v188
    v_add_f32 v209, v209, v189
    v_mfma_f32_16x16x32_bf16 v[216:219], v[56:59], v[124:127], v[216:219]
    v_add_f32 v210, v210, v190
    v_add_f32 v211, v211, v191
    v_mfma_f32_16x16x32_bf16 v[220:223], v[60:63], v[124:127], v[220:223]
    ds_write_b128 v11, v[208:211] offset:44032
    s_waitcnt lgkmcnt(3)
    v_add_f32 v212, v212, v192
    v_add_f32 v213, v213, v193
    v_mfma_f32_16x16x32_bf16 v[224:227], v[64:67], v[124:127], v[224:227]
    v_add_f32 v214, v214, v194
    v_add_f32 v215, v215, v195
    v_mfma_f32_16x16x32_bf16 v[228:231], v[68:71], v[124:127], v[228:231]
    ds_write_b128 v11, v[212:215] offset:45056
    v_mfma_f32_16x16x32_bf16 v[232:235], v[72:75], v[124:127], v[232:235]
    v_mfma_f32_16x16x32_bf16 v[216:219], v[76:79], v[128:131], v[216:219]
    v_mfma_f32_16x16x32_bf16 v[220:223], v[80:83], v[128:131], v[220:223]
    v_mfma_f32_16x16x32_bf16 v[224:227], v[84:87], v[128:131], v[224:227]
    v_mfma_f32_16x16x32_bf16 v[228:231], v[88:91], v[128:131], v[228:231]
    v_mfma_f32_16x16x32_bf16 v[232:235], v[92:95], v[128:131], v[232:235]
    s_waitcnt lgkmcnt(0)
    s_barrier
    ds_read_b128 v[136:139], v14 offset:40960
    v_mfma_f32_16x16x32_bf16 v[216:219], v[96:99], v[132:135], v[216:219]
    ds_read_b128 v[140:143], v14 offset:41984
    v_mfma_f32_16x16x32_bf16 v[220:223], v[100:103], v[132:135], v[220:223]
    ds_read_b128 v[144:147], v14 offset:43008
    v_mfma_f32_16x16x32_bf16 v[224:227], v[104:107], v[132:135], v[224:227]
    ds_read_b128 v[148:151], v14 offset:44032
    v_mfma_f32_16x16x32_bf16 v[228:231], v[108:111], v[132:135], v[228:231]
    ds_read_b128 v[152:155], v14 offset:45056
    v_mfma_f32_16x16x32_bf16 v[232:235], v[112:115], v[132:135], v[232:235]
    v_pk_add_f32 v[156:157], v[156:157], v[216:217]
    v_pk_add_f32 v[158:159], v[158:159], v[218:219]
    v_pk_add_f32 v[160:161], v[160:161], v[220:221]
    v_pk_add_f32 v[162:163], v[162:163], v[222:223]
    v_pk_add_f32 v[164:165], v[164:165], v[224:225]
    v_pk_add_f32 v[166:167], v[166:167], v[226:227]
    v_pk_add_f32 v[168:169], v[168:169], v[228:229]
    v_pk_add_f32 v[170:171], v[170:171], v[230:231]
    v_pk_add_f32 v[172:173], v[172:173], v[232:233]
    v_pk_add_f32 v[174:175], v[174:175], v[234:235]
    s_waitcnt lgkmcnt(0)
    v_pk_add_f32 v[156:157], v[156:157], v[136:137]
    v_pk_add_f32 v[158:159], v[158:159], v[138:139]
    v_pk_add_f32 v[160:161], v[160:161], v[140:141]
    v_pk_add_f32 v[162:163], v[162:163], v[142:143]
    v_pk_add_f32 v[164:165], v[164:165], v[144:145]
    v_pk_add_f32 v[166:167], v[166:167], v[146:147]
    v_pk_add_f32 v[168:169], v[168:169], v[148:149]
    v_pk_add_f32 v[170:171], v[170:171], v[150:151]
    v_pk_add_f32 v[172:173], v[172:173], v[152:153]
    v_pk_add_f32 v[174:175], v[174:175], v[154:155]
    v_mov_b32 v40, 0
    v_mov_b32 v41, 0
    v_mov_b32 v42, 0
    v_mov_b32 v43, s33
    v_cvt_pk_bf16_f32 v236, v156, v157
    v_cvt_pk_bf16_f32 v237, v158, v159
    v_cvt_pk_bf16_f32 v238, v160, v161
    v_cvt_pk_bf16_f32 v239, v162, v163
    v_cvt_pk_bf16_f32 v240, v164, v165
    v_cvt_pk_bf16_f32 v241, v166, v167
    v_cvt_pk_bf16_f32 v242, v168, v169
    v_cvt_pk_bf16_f32 v243, v170, v171
    v_cvt_pk_bf16_f32 v244, v172, v173
    v_cvt_pk_bf16_f32 v245, v174, v175
    v_dot2c_f32_bf16 v40, s19, v236
    v_dot2c_f32_bf16 v41, v236, v236
    v_dot2c_f32_bf16 v42, v246, v236
    v_dot2c_f32_bf16 v40, s19, v237
    v_dot2c_f32_bf16 v41, v237, v237
    v_dot2c_f32_bf16 v42, v247, v237
    v_dot2c_f32_bf16 v40, s19, v238
    v_dot2c_f32_bf16 v41, v238, v238
    v_dot2c_f32_bf16 v42, v248, v238
    v_dot2c_f32_bf16 v40, s19, v239
    v_dot2c_f32_bf16 v41, v239, v239
    v_dot2c_f32_bf16 v42, v249, v239
    v_dot2c_f32_bf16 v40, s19, v240
    v_dot2c_f32_bf16 v41, v240, v240
    v_dot2c_f32_bf16 v42, v250, v240
    v_dot2c_f32_bf16 v40, s19, v241
    v_dot2c_f32_bf16 v41, v241, v241
    v_dot2c_f32_bf16 v42, v251, v241
    v_dot2c_f32_bf16 v40, s19, v242
    v_dot2c_f32_bf16 v41, v242, v242
    v_dot2c_f32_bf16 v42, v252, v242
    v_dot2c_f32_bf16 v40, s19, v243
    v_dot2c_f32_bf16 v41, v243, v243
    v_dot2c_f32_bf16 v42, v253, v243
    v_dot2c_f32_bf16 v40, s19, v244
    v_dot2c_f32_bf16 v41, v244, v244
    v_dot2c_f32_bf16 v42, v254, v244
    v_dot2c_f32_bf16 v40, s19, v245
    v_dot2c_f32_bf16 v41, v245, v245
    v_dot2c_f32_bf16 v42, v255, v245
    s_nop 2
    v_mov_b32 v44, v40
    v_mov_b32 v45, v41
    v_mov_b32 v46, v42
    v_permlane16_swap_b32 v40, v44
    v_permlane16_swap_b32 v41, v45
    v_permlane16_swap_b32 v42, v46
    v_add_f32 v40, v40, v44
    v_add_f32 v41, v41, v45
    v_add_f32 v42, v42, v46
    v_mov_b32 v44, v40
    v_mov_b32 v45, v41
    v_mov_b32 v46, v42
    v_permlane32_swap_b32 v40, v44
    v_permlane32_swap_b32 v41, v45
    v_permlane32_swap_b32 v42, v46
    v_add_f32 v40, v40, v44
    v_add_f32 v41, v41, v45
    v_add_f32 v42, v42, v46
    buffer_store_dwordx4 v[40:43], v10, s[8:11], s28 offen sc1
    s_barrier
    s_sleep 16
    v_add_u32 v9, 4096, v15
    buffer_load_dwordx4 v[48:51], v15, s[8:11], s29 offen sc1
    buffer_load_dwordx4 v[52:55], v9, s[8:11], s29 offen sc1
    v_lshlrev_b32 v156, 16, v236
    v_and_b32 v157, 0xffff0000, v236
    v_lshlrev_b32 v158, 16, v237
    v_and_b32 v159, 0xffff0000, v237
    v_lshlrev_b32 v160, 16, v238
    v_and_b32 v161, 0xffff0000, v238
    v_lshlrev_b32 v162, 16, v239
    v_and_b32 v163, 0xffff0000, v239
    v_lshlrev_b32 v164, 16, v240
    v_and_b32 v165, 0xffff0000, v240
    v_lshlrev_b32 v166, 16, v241
    v_and_b32 v167, 0xffff0000, v241
    v_lshlrev_b32 v168, 16, v242
    v_and_b32 v169, 0xffff0000, v242
    v_lshlrev_b32 v170, 16, v243
    v_and_b32 v171, 0xffff0000, v243
    v_lshlrev_b32 v172, 16, v244
    v_and_b32 v173, 0xffff0000, v244
    v_lshlrev_b32 v174, 16, v245
    v_and_b32 v175, 0xffff0000, v245
    v_mov_b32 v60, v236
    v_mov_b32 v61, s33
    v_mov_b32 v62, v237
    v_mov_b32 v63, s33
    v_mov_b32 v64, v238
    v_mov_b32 v65, s33
    v_mov_b32 v66, v239
    v_mov_b32 v67, s33
    v_mov_b32 v68, v240
    v_mov_b32 v69, s33
    v_mov_b32 v70, v241
    v_mov_b32 v71, s33
    v_mov_b32 v72, v242
    v_mov_b32 v73, s33
    v_mov_b32 v74, v243
    v_mov_b32 v75, s33
    v_mov_b32 v76, v244
    v_mov_b32 v77, s33
    v_mov_b32 v78, v245
    v_mov_b32 v79, s33
    v_add_u32 v1, s32, v5
    v_mov_b32 v2, 0x3acccccd
    v_mov_b32 v3, 0x80000000
    v_mul_u32_u24 v11, 80, v6
    s_mov_b32 s26, 0x7ff
    v_mov_b32 v59, s33
    v_lshl_or_b32 v12, v6, 30, s59
    v_mov_b32 v13, 0
    s_lshl_b32 s17, s14, 2
    v_mov_b32 v14, s17
    s_mov_b32 s48, 262144
    s_branch KT_GS1
KT_GS:
KT_GS0:
    buffer_load_dwordx4 v[48:51], v15, s[8:11], s29 offen sc1
    buffer_load_dwordx4 v[52:55], v9, s[8:11], s29 offen sc1
KT_GS1:
    s_waitcnt vmcnt(0)
    v_cmp_ne_u32 vcc, s33, v51
    v_cmp_ne_u32 s[50:51], s33, v55
    s_or_b64 vcc, vcc, s[50:51]
    s_cbranch_vccz KT_GS2
    s_sub_u32 s48, s48, 1
    s_cbranch_scc0 KT_GS
KT_GS2:
    v_add_f32 v48, v48, v52
    v_add_f32 v49, v49, v53
    v_add_f32 v50, v50, v54
    v_mov_b32 v52, v48
    v_mov_b32 v53, v49
    v_mov_b32 v54, v50
    v_permlane16_swap_b32 v48, v52
    v_permlane16_swap_b32 v49, v53
    v_permlane16_swap_b32 v50, v54
    v_add_f32 v48, v48, v52
    v_add_f32 v49, v49, v53
    v_add_f32 v50, v50, v54
    v_mov_b32 v52, v48
    v_mov_b32 v53, v49
    v_mov_b32 v54, v50
    v_permlane32_swap_b32 v48, v52
    v_permlane32_swap_b32 v49, v53
    v_permlane32_swap_b32 v50, v54
    v_add_f32 v48, v48, v52
    v_add_f32 v49, v49, v53
    v_add_f32 v50, v50, v54
    v_mul_f32 v57, v2, v48
    v_fmaak_f32 v58, v2, v49, 0x3727c5ac
    v_fma_f32 v58, -v57, v57, v58
    v_max_f32 v58, 0x3727c5ac, v58
    v_rsq_f32 v58, v58
    v_fma_f32 v56, -v57, s49, v50
    v_mul_f32 v56, v56, v58
    v_mul_f32 v52, -v57, v58
    v_ashrrev_i32 v54, 31, v56
    v_add_f32 v53, 1.0, v58
    v_lshrrev_b32 v54, 1, v54
    v_xor_b32 v56, v56, v54
    v_bfi_b32 v56, s26, v1, v56
    s_nop 1
    v_max_i32_dpp v54, v56, v56 quad_perm:[1,0,3,2] row_mask:0xf bank_mask:0xf
    s_nop 1
    v_max_i32_dpp v54, v54, v54 quad_perm:[2,3,0,1] row_mask:0xf bank_mask:0xf
    s_nop 1
    v_max_i32_dpp v54, v54, v54 row_half_mirror row_mask:0xf bank_mask:0xf
    s_nop 1
    v_max_i32_dpp v54, v54, v54 row_mirror row_mask:0xf bank_mask:0xf
    s_nop 1
    ds_write_b32 v14, v54 offset:61456
    v_pk_fma_f32 v[156:157], v[156:157], v[52:53], v[52:53] op_sel:[0,1,0] op_sel_hi:[1,1,0]
    v_pk_fma_f32 v[158:159], v[158:159], v[52:53], v[52:53] op_sel:[0,1,0] op_sel_hi:[1,1,0]
    v_pk_fma_f32 v[160:161], v[160:161], v[52:53], v[52:53] op_sel:[0,1,0] op_sel_hi:[1,1,0]
    v_pk_fma_f32 v[162:163], v[162:163], v[52:53], v[52:53] op_sel:[0,1,0] op_sel_hi:[1,1,0]
    v_pk_fma_f32 v[164:165], v[164:165], v[52:53], v[52:53] op_sel:[0,1,0] op_sel_hi:[1,1,0]
    v_pk_fma_f32 v[166:167], v[166:167], v[52:53], v[52:53] op_sel:[0,1,0] op_sel_hi:[1,1,0]
    v_pk_fma_f32 v[168:169], v[168:169], v[52:53], v[52:53] op_sel:[0,1,0] op_sel_hi:[1,1,0]
    v_pk_fma_f32 v[170:171], v[170:171], v[52:53], v[52:53] op_sel:[0,1,0] op_sel_hi:[1,1,0]
    v_pk_fma_f32 v[172:173], v[172:173], v[52:53], v[52:53] op_sel:[0,1,0] op_sel_hi:[1,1,0]
    v_pk_fma_f32 v[174:175], v[174:175], v[52:53], v[52:53] op_sel:[0,1,0] op_sel_hi:[1,1,0]
    s_waitcnt lgkmcnt(0)
    s_barrier
    ds_read_b128 v[48:51], v13 offset:61456
    v_cvt_pk_bf16_f32 v236, v156, v157
    v_cvt_pk_bf16_f32 v237, v158, v159
    v_cvt_pk_bf16_f32 v238, v160, v161
    v_cvt_pk_bf16_f32 v239, v162, v163
    v_cvt_pk_bf16_f32 v240, v164, v165
    v_cvt_pk_bf16_f32 v241, v166, v167
    v_cvt_pk_bf16_f32 v242, v168, v169
    v_cvt_pk_bf16_f32 v243, v170, v171
    v_cvt_pk_bf16_f32 v244, v172, v173
    v_cvt_pk_bf16_f32 v245, v174, v175
    s_waitcnt lgkmcnt(0)
    v_max3_i32 v54, v48, v49, v50
    v_max_i32 v54, v54, v51
    v_cmp_eq_u32 vcc, v54, v56
    s_nop 1
    v_cndmask_b32 v12, v3, v12, vcc
    v_cndmask_b32 v11, v3, v11, vcc
    v_cndmask_b32 v7, v8, v3, vcc
    v_cndmask_b32 v8, v3, v8, vcc
    buffer_store_dwordx4 v[56:59], v12, s[8:11], s31 offen sc1
    buffer_store_dwordx4 v[60:63], v11, s[8:11], s30 offen offset:0 sc1
    buffer_store_dwordx4 v[64:67], v11, s[8:11], s30 offen offset:16 sc1
    buffer_store_dwordx4 v[68:71], v11, s[8:11], s30 offen offset:32 sc1
    buffer_store_dwordx4 v[72:75], v11, s[8:11], s30 offen offset:48 sc1
    buffer_store_dwordx4 v[76:79], v11, s[8:11], s30 offen offset:64 sc1
    buffer_store_dwordx4 v[236:239], v7, s[40:43], s18 offen nt
    buffer_store_dwordx4 v[240:243], v7, s[40:43], s18 offen offset:16 nt
    buffer_store_dwordx2 v[244:245], v7, s[40:43], s18 offen offset:32 nt
    s_cbranch_vccz KT_GE
    s_mov_b32 s48, 262144
KT_GB:
    ds_read_b128 v[48:51], v13 offset:61440
    s_waitcnt lgkmcnt(0)
    v_readfirstlane_b32 s26, v51
    v_readfirstlane_b32 s27, v48
    s_cmp_eq_u32 s26, s33
    s_cbranch_scc1 KT_GB2
    s_sleep 1
    s_sub_u32 s48, s48, 1
    s_cbranch_scc0 KT_GB
KT_GB2:
    s_and_b32 s27, s27, 0x7ff
    s_nop 0
    v_cmp_eq_u32 vcc, s27, v1
    s_nop 1
    v_cndmask_b32 v8, v8, v3, vcc
    buffer_store_dwordx4 v[236:239], v8, s[40:43], s18 offen nt
    buffer_store_dwordx4 v[240:243], v8, s[40:43], s18 offen offset:16 nt
    buffer_store_dwordx2 v[244:245], v8, s[40:43], s18 offen offset:32 nt
KT_GE:
    s_endpgm
K2_CT:
    v_readfirstlane_b32 s33, v60
    s_mov_b32 s14, s26
    s_mov_b32 s6, s10
    s_mov_b64 s[4:5], s[8:9]
    s_mov_b32 s10, 0xe4c400
    s_mov_b32 s11, 0x00020000
    s_mov_b32 s12, s101
    s_mov_b32 s15, s96
    s_mov_b32 s17, s97
    s_mov_b32 s24, s98
    s_add_u32 s25, s98, 32768
    s_mov_b32 s27, s99
    s_mov_b32 s22, 0
    s_mov_b32 s20, -4
    s_mov_b32 s21, 4
    v_mov_b32 v4, v184
    v_mov_b32 v5, v185
    v_mov_b32 v6, v186
    v_mov_b32 v3, v187
    v_mov_b32 v7, v188
    v_mov_b32 v61, 1
    v_mov_b32 v63, s33
    s_mov_b64 exec, 1
    s_waitcnt vmcnt(0)
    ds_add_rtn_u32 v62, v191, v61
    s_waitcnt lgkmcnt(0)
    v_readfirstlane_b32 s46, v62
    s_cmp_lg_u32 s46, 3
    s_cbranch_scc1 K2_CW
    buffer_store_dword v63, off, s[8:11], s100 sc1
K2_CW:
    s_mov_b64 exec, -1
    s_mov_b32 s13, 0
    v_mov_b32 v116, 0
    v_mov_b32 v117, 0
    v_mov_b32 v118, 0
    v_mov_b32 v119, 0
    v_mov_b32 v120, 0
    v_mov_b32 v121, 0
    v_mov_b32 v122, 0
    v_mov_b32 v123, 0
    v_mov_b32 v124, 0
    v_mov_b32 v125, 0
    v_mov_b32 v126, 0
    v_mov_b32 v127, 0
    v_mov_b32 v128, 0
    v_mov_b32 v129, 0
    v_mov_b32 v130, 0
    v_mov_b32 v131, 0
    v_mov_b32 v132, 0
    v_mov_b32 v133, 0
    v_mov_b32 v134, 0
    v_mov_b32 v135, 0
    v_mov_b32 v136, 0
    v_mov_b32 v137, 0
    v_mov_b32 v138, 0
    v_mov_b32 v139, 0
    v_mov_b32 v140, 0
    v_mov_b32 v141, 0
    v_mov_b32 v142, 0
    v_mov_b32 v143, 0
    v_mov_b32 v144, 0
    v_mov_b32 v145, 0
    v_mov_b32 v146, 0
    v_mov_b32 v147, 0
    v_mov_b32 v24, 0
    v_mov_b32 v25, 0
    v_mov_b32 v26, 0
    v_mov_b32 v27, 0
    v_mov_b32 v80, 0
    v_mov_b32 v81, 0
    v_mov_b32 v82, 0
    v_mov_b32 v83, 0
    v_mov_b32 v40, 0
    v_mov_b32 v41, 0
    v_mov_b32 v42, 0
    v_mov_b32 v43, 0
    v_mov_b32 v44, 0
    v_mov_b32 v45, 0
    v_mov_b32 v46, 0
    v_mov_b32 v47, 0
    v_mov_b32 v48, 0
    v_mov_b32 v49, 0
    v_mov_b32 v50, 0
    v_mov_b32 v51, 0
    v_mov_b32 v52, 0
    v_mov_b32 v53, 0
    v_mov_b32 v54, 0
    v_mov_b32 v55, 0
    s_mov_b32 exec_lo, 0x100000
    s_mov_b32 exec_hi, 0x100000
    v_mov_b32 v40, 0x3f803f80
    v_mov_b32 v41, 0x3f803f80
    v_mov_b32 v42, 0x3f803f80
    v_mov_b32 v43, 0x3f803f80
    v_mov_b32 v44, 0x3f803f80
    v_mov_b32 v45, 0x3f803f80
    v_mov_b32 v46, 0x3f803f80
    v_mov_b32 v47, 0x3f803f80
    v_mov_b32 v48, 0x3f803f80
    v_mov_b32 v49, 0x3f803f80
    v_mov_b32 v50, 0x3f803f80
    v_mov_b32 v51, 0x3f803f80
    v_mov_b32 v52, 0x3f803f80
    v_mov_b32 v53, 0x3f803f80
    v_mov_b32 v54, 0x3f803f80
    v_mov_b32 v55, 0x3f803f80
    s_mov_b64 exec, -1
    s_mov_b32 s48, 262144
K2_W0:
    ds_read_b32 v62, v191 offset:16
    s_waitcnt lgkmcnt(0)
    v_readfirstlane_b32 s46, v62
    s_cmp_eq_u32 s46, s33
    s_cbranch_scc1 K2_W02
    s_sleep 1
    s_sub_u32 s48, s48, 1
    s_cbranch_scc0 K2_W0
K2_W02:
    buffer_load_dwordx4 v[8:11], v4, s[8:11], s17 offen
    buffer_load_dwordx2 v[16:17], v3, s[8:11], s17 offen
    buffer_load_dwordx4 v[12:15], v4, s[8:11], s17 offen offset:1024
    buffer_load_dwordx4 v[28:31], v4, s[8:11], s15 offen
    buffer_load_dwordx4 v[36:39], v5, s[8:11], s15 offen
    buffer_load_dwordx4 v[32:35], v4, s[8:11], s15 offen offset:1024
    s_mov_b32 s48, 262144
K2_W3:
    ds_read_b32 v62, v191 offset:4
    s_waitcnt lgkmcnt(0)
    v_readfirstlane_b32 s46, v62
    s_cmp_eq_u32 s46, s33
    s_cbranch_scc1 K2_W32
    s_sleep 1
    s_sub_u32 s48, s48, 1
    s_cbranch_scc0 K2_W3
K2_W32:
    s_mov_b32 exec_lo, 0xfffff
    s_mov_b32 exec_hi, 0xfffff
    s_mov_b32 s46, 5242880
    buffer_load_dwordx4 v[40:43], v7, s[8:11], s46 offen
    s_mov_b32 s46, 5263360
    buffer_load_dwordx4 v[44:47], v7, s[8:11], s46 offen
    s_mov_b32 s46, 5283840
    buffer_load_dwordx4 v[48:51], v7, s[8:11], s46 offen
    s_mov_b32 s46, 5304320
    buffer_load_dwordx4 v[52:55], v7, s[8:11], s46 offen
    s_mov_b64 exec, -1
K2_RAW:
    s_waitcnt vmcnt(5)
    v_mfma_f32_32x32x16_bf16 v[84:99], v[28:31], v[8:11], 0
    v_mfma_f32_32x32x16_bf16 v[100:115], v[28:31], v[12:15], 0
    v_mov_b32 v1, v4
    v_mov_b32 v2, v5
    v_mov_b32 v3, v6
    s_nop 6
    v_mfma_f32_32x32x4_2b_bf16 v[84:115], v[36:37], v[16:17], v[84:115] cbsz:1 abid:0
    s_nop 15
    s_nop 1
    s_cmp_lg_u32 s22, 0
    s_cbranch_scc1 K2_JOIN
    v_max3_f32 v182, v84, v85, v86
    v_max3_f32 v183, v100, v101, v102
    v_max3_f32 v182, v182, v87, v88
    v_max3_f32 v183, v183, v103, v104
    v_max3_f32 v182, v182, v89, v90
    v_max3_f32 v183, v183, v105, v106
    v_max3_f32 v182, v182, v91, v92
    v_max3_f32 v183, v183, v107, v108
    v_max3_f32 v182, v182, v93, v94
    v_max3_f32 v183, v183, v109, v110
    v_max3_f32 v182, v182, v95, v96
    v_max3_f32 v183, v183, v111, v112
    v_max3_f32 v182, v182, v97, v98
    v_max3_f32 v183, v183, v113, v114
    v_max_f32 v182, v182, v99
    v_max_f32 v183, v183, v115
K2_JOIN:
    v_mov_b32 v184, v182
    v_mov_b32 v185, v183
    s_nop 0
    v_permlane32_swap_b32 v182, v184
    v_permlane32_swap_b32 v183, v185
    v_max_f32 v182, v182, v184
    v_max_f32 v183, v183, v185
    v_pk_add_f32 v[148:149], v[182:183], 0 op_sel:[0,0] op_sel_hi:[0,0] neg_lo:[1,0] neg_hi:[1,0]
    v_pk_add_f32 v[150:151], v[182:183], 0 op_sel:[0,0] op_sel_hi:[0,0] neg_lo:[1,0] neg_hi:[1,0]
    v_pk_add_f32 v[152:153], v[182:183], 0 op_sel:[0,0] op_sel_hi:[0,0] neg_lo:[1,0] neg_hi:[1,0]
    v_pk_add_f32 v[154:155], v[182:183], 0 op_sel:[0,0] op_sel_hi:[0,0] neg_lo:[1,0] neg_hi:[1,0]
    v_pk_add_f32 v[156:157], v[182:183], 0 op_sel:[0,0] op_sel_hi:[0,0] neg_lo:[1,0] neg_hi:[1,0]
    v_pk_add_f32 v[158:159], v[182:183], 0 op_sel:[0,0] op_sel_hi:[0,0] neg_lo:[1,0] neg_hi:[1,0]
    v_pk_add_f32 v[160:161], v[182:183], 0 op_sel:[0,0] op_sel_hi:[0,0] neg_lo:[1,0] neg_hi:[1,0]
    v_pk_add_f32 v[162:163], v[182:183], 0 op_sel:[0,0] op_sel_hi:[0,0] neg_lo:[1,0] neg_hi:[1,0]
    v_pk_add_f32 v[164:165], v[182:183], 0 op_sel:[1,0] op_sel_hi:[1,0] neg_lo:[1,0] neg_hi:[1,0]
    v_pk_add_f32 v[166:167], v[182:183], 0 op_sel:[1,0] op_sel_hi:[1,0] neg_lo:[1,0] neg_hi:[1,0]
    v_pk_add_f32 v[168:169], v[182:183], 0 op_sel:[1,0] op_sel_hi:[1,0] neg_lo:[1,0] neg_hi:[1,0]
    v_pk_add_f32 v[170:171], v[182:183], 0 op_sel:[1,0] op_sel_hi:[1,0] neg_lo:[1,0] neg_hi:[1,0]
    v_pk_add_f32 v[172:173], v[182:183], 0 op_sel:[1,0] op_sel_hi:[1,0] neg_lo:[1,0] neg_hi:[1,0]
    v_pk_add_f32 v[174:175], v[182:183], 0 op_sel:[1,0] op_sel_hi:[1,0] neg_lo:[1,0] neg_hi:[1,0]
    v_pk_add_f32 v[176:177], v[182:183], 0 op_sel:[1,0] op_sel_hi:[1,0] neg_lo:[1,0] neg_hi:[1,0]
    v_pk_add_f32 v[178:179], v[182:183], 0 op_sel:[1,0] op_sel_hi:[1,0] neg_lo:[1,0] neg_hi:[1,0]
    v_pk_add_f32 v[84:85], v[84:85], v[148:149]
    v_pk_add_f32 v[86:87], v[86:87], v[148:149]
    v_pk_add_f32 v[88:89], v[88:89], v[148:149]
    v_pk_add_f32 v[90:91], v[90:91], v[148:149]
    v_pk_add_f32 v[92:93], v[92:93], v[148:149]
    v_pk_add_f32 v[94:95], v[94:95], v[148:149]
    v_pk_add_f32 v[96:97], v[96:97], v[148:149]
    v_pk_add_f32 v[98:99], v[98:99], v[148:149]
    v_pk_add_f32 v[100:101], v[100:101], v[164:165]
    v_pk_add_f32 v[102:103], v[102:103], v[164:165]
    v_pk_add_f32 v[104:105], v[104:105], v[164:165]
    v_pk_add_f32 v[106:107], v[106:107], v[164:165]
    v_pk_add_f32 v[108:109], v[108:109], v[164:165]
    v_pk_add_f32 v[110:111], v[110:111], v[164:165]
    v_pk_add_f32 v[112:113], v[112:113], v[164:165]
    v_pk_add_f32 v[114:115], v[114:115], v[164:165]
    s_waitcnt vmcnt(0)
    s_cmp_lg_u32 s22, 0
    s_cbranch_scc1 K2_NOBAR
.p2align 5
K2_BAR:
    s_barrier
K2_NOBAR:
    v_mfma_f32_32x32x16_bf16 v[186:201], v[32:35], v[8:11], v[148:163]
    ds_read_b128 v[56:59], v1 offset:0
    ds_read_b128 v[64:67], v2 offset:0
    v_exp_f32 v84, v84
    v_exp_f32 v85, v85
    v_exp_f32 v86, v86
    v_exp_f32 v87, v87
    v_exp_f32 v88, v88
    v_mfma_f32_32x32x16_bf16 v[132:147], v[80:83], v[24:27], v[132:147]
    ds_read_b128 v[60:63], v1 offset:1024
    v_exp_f32 v89, v89
    v_cvt_pk_bf16_f32 v20, v84, v85
    v_exp_f32 v90, v90
    v_cvt_pk_bf16_f32 v21, v86, v87
    v_exp_f32 v91, v91
    v_cvt_pk_bf16_f32 v22, v88, v89
    v_mfma_f32_32x32x16_bf16 v[202:217], v[32:35], v[12:15], v[164:179]
    ds_read_b128 v[68:71], v3 offset:0
    v_exp_f32 v92, v92
    v_cvt_pk_bf16_f32 v23, v90, v91
    v_exp_f32 v93, v93
    v_exp_f32 v94, v94
    v_exp_f32 v95, v95
    v_mfma_f32_32x32x16_bf16 v[116:131], v[40:43], v[20:23], v[116:131]
    ds_read_b128 v[72:75], v3 offset:672
    v_exp_f32 v96, v96
    v_exp_f32 v97, v97
    v_exp_f32 v98, v98
    v_exp_f32 v99, v99
    v_cvt_pk_bf16_f32 v24, v92, v93
    v_cvt_pk_bf16_f32 v25, v94, v95
    v_cvt_pk_bf16_f32 v26, v96, v97
    v_cvt_pk_bf16_f32 v27, v98, v99
    v_mfma_f32_32x32x4_2b_bf16 v[186:217], v[38:39], v[16:17], v[186:217] cbsz:1 abid:0
    ds_read_b128 v[76:79], v3 offset:1344
    ds_read_b128 v[80:83], v3 offset:2016
    v_exp_f32 v100, v100
    v_exp_f32 v101, v101
    v_exp_f32 v102, v102
    v_exp_f32 v103, v103
    v_exp_f32 v104, v104
    v_exp_f32 v105, v105
    v_exp_f32 v106, v106
    v_exp_f32 v107, v107
    v_exp_f32 v108, v108
    v_mfma_f32_32x32x16_bf16 v[116:131], v[44:47], v[24:27], v[116:131]
    v_cvt_pk_bf16_f32 v20, v100, v101
    v_cvt_pk_bf16_f32 v21, v102, v103
    v_cvt_pk_bf16_f32 v22, v104, v105
    v_cvt_pk_bf16_f32 v23, v106, v107
    v_exp_f32 v109, v109
    v_exp_f32 v110, v110
    v_exp_f32 v111, v111
    v_mfma_f32_32x32x16_bf16 v[132:147], v[40:43], v[20:23], v[132:147]
    s_waitcnt lgkmcnt(0)
    v_exp_f32 v112, v112
    v_exp_f32 v113, v113
    v_exp_f32 v114, v114
    v_exp_f32 v115, v115
    v_cvt_pk_bf16_f32 v24, v108, v109
    v_cvt_pk_bf16_f32 v25, v110, v111
    v_cvt_pk_bf16_f32 v26, v112, v113
    v_cvt_pk_bf16_f32 v27, v114, v115
    v_mfma_f32_32x32x16_bf16 v[84:99], v[56:59], v[8:11], v[148:163]
    v_exp_f32 v186, v186
    v_exp_f32 v187, v187
    v_exp_f32 v188, v188
    v_exp_f32 v189, v189
    v_exp_f32 v190, v190
    v_mfma_f32_32x32x16_bf16 v[132:147], v[44:47], v[24:27], v[132:147]
    v_exp_f32 v191, v191
    v_cvt_pk_bf16_f32 v20, v186, v187
    v_exp_f32 v192, v192
    v_cvt_pk_bf16_f32 v21, v188, v189
    v_exp_f32 v193, v193
    v_cvt_pk_bf16_f32 v22, v190, v191
    v_mfma_f32_32x32x16_bf16 v[100:115], v[56:59], v[12:15], v[164:179]
    v_exp_f32 v194, v194
    v_cvt_pk_bf16_f32 v23, v192, v193
    v_exp_f32 v195, v195
    v_exp_f32 v196, v196
    v_exp_f32 v197, v197
    v_mfma_f32_32x32x16_bf16 v[116:131], v[48:51], v[20:23], v[116:131]
    v_exp_f32 v198, v198
    v_exp_f32 v199, v199
    v_exp_f32 v200, v200
    v_exp_f32 v201, v201
    v_cvt_pk_bf16_f32 v24, v194, v195
    v_cvt_pk_bf16_f32 v25, v196, v197
    v_cvt_pk_bf16_f32 v26, v198, v199
    v_cvt_pk_bf16_f32 v27, v200, v201
    v_mfma_f32_32x32x4_2b_bf16 v[84:115], v[64:65], v[16:17], v[84:115] cbsz:1 abid:0
    v_exp_f32 v202, v202
    v_exp_f32 v203, v203
    v_exp_f32 v204, v204
    v_exp_f32 v205, v205
    v_exp_f32 v206, v206
    v_exp_f32 v207, v207
    v_exp_f32 v208, v208
    v_exp_f32 v209, v209
    v_exp_f32 v210, v210
    v_mfma_f32_32x32x16_bf16 v[116:131], v[52:55], v[24:27], v[116:131]
    v_cvt_pk_bf16_f32 v20, v202, v203
    v_cvt_pk_bf16_f32 v21, v204, v205
    v_cvt_pk_bf16_f32 v22, v206, v207
    v_cvt_pk_bf16_f32 v23, v208, v209
    v_exp_f32 v211, v211
    v_exp_f32 v212, v212
    v_exp_f32 v213, v213
    v_mfma_f32_32x32x16_bf16 v[132:147], v[48:51], v[20:23], v[132:147]
    v_exp_f32 v214, v214
    v_exp_f32 v215, v215
    v_exp_f32 v216, v216
    v_exp_f32 v217, v217
    v_cvt_pk_bf16_f32 v24, v210, v211
    v_cvt_pk_bf16_f32 v25, v212, v213
    v_cvt_pk_bf16_f32 v26, v214, v215
    v_cvt_pk_bf16_f32 v27, v216, v217
    v_mfma_f32_32x32x16_bf16 v[186:201], v[60:63], v[8:11], v[148:163]
    ds_read_b128 v[28:31], v1 offset:5248
    ds_read_b128 v[36:39], v2 offset:5248
    v_exp_f32 v84, v84
    v_exp_f32 v85, v85
    v_exp_f32 v86, v86
    v_exp_f32 v87, v87
    v_exp_f32 v88, v88
    v_mfma_f32_32x32x16_bf16 v[132:147], v[52:55], v[24:27], v[132:147]
    ds_read_b128 v[32:35], v1 offset:6272
    v_exp_f32 v89, v89
    v_cvt_pk_bf16_f32 v20, v84, v85
    v_exp_f32 v90, v90
    v_cvt_pk_bf16_f32 v21, v86, v87
    v_exp_f32 v91, v91
    v_cvt_pk_bf16_f32 v22, v88, v89
    v_mfma_f32_32x32x16_bf16 v[202:217], v[60:63], v[12:15], v[164:179]
    ds_read_b128 v[40:43], v3 offset:5248
    v_exp_f32 v92, v92
    v_cvt_pk_bf16_f32 v23, v90, v91
    v_exp_f32 v93, v93
    v_exp_f32 v94, v94
    v_exp_f32 v95, v95
    v_mfma_f32_32x32x16_bf16 v[116:131], v[68:71], v[20:23], v[116:131]
    ds_read_b128 v[44:47], v3 offset:5920
    v_exp_f32 v96, v96
    v_exp_f32 v97, v97
    v_exp_f32 v98, v98
    v_exp_f32 v99, v99
    v_cvt_pk_bf16_f32 v24, v92, v93
    v_cvt_pk_bf16_f32 v25, v94, v95
    v_cvt_pk_bf16_f32 v26, v96, v97
    v_cvt_pk_bf16_f32 v27, v98, v99
    v_mfma_f32_32x32x4_2b_bf16 v[186:217], v[66:67], v[16:17], v[186:217] cbsz:1 abid:0
    ds_read_b128 v[48:51], v3 offset:6592
    ds_read_b128 v[52:55], v3 offset:7264
    v_exp_f32 v100, v100
    v_exp_f32 v101, v101
    v_exp_f32 v102, v102
    v_exp_f32 v103, v103
    v_exp_f32 v104, v104
    v_exp_f32 v105, v105
    v_exp_f32 v106, v106
    v_exp_f32 v107, v107
    v_exp_f32 v108, v108
    v_mfma_f32_32x32x16_bf16 v[116:131], v[72:75], v[24:27], v[116:131]
    v_cvt_pk_bf16_f32 v20, v100, v101
    v_cvt_pk_bf16_f32 v21, v102, v103
    v_cvt_pk_bf16_f32 v22, v104, v105
    v_cvt_pk_bf16_f32 v23, v106, v107
    v_exp_f32 v109, v109
    v_exp_f32 v110, v110
    v_exp_f32 v111, v111
    v_mfma_f32_32x32x16_bf16 v[132:147], v[68:71], v[20:23], v[132:147]
    s_waitcnt lgkmcnt(0)
    v_exp_f32 v112, v112
    v_exp_f32 v113, v113
    v_exp_f32 v114, v114
    v_exp_f32 v115, v115
    v_cvt_pk_bf16_f32 v24, v108, v109
    v_cvt_pk_bf16_f32 v25, v110, v111
    v_cvt_pk_bf16_f32 v26, v112, v113
    v_cvt_pk_bf16_f32 v27, v114, v115
    v_mfma_f32_32x32x16_bf16 v[84:99], v[28:31], v[8:11], v[148:163]
    v_exp_f32 v186, v186
    v_exp_f32 v187, v187
    v_exp_f32 v188, v188
    v_exp_f32 v189, v189
    v_exp_f32 v190, v190
    v_mfma_f32_32x32x16_bf16 v[132:147], v[72:75], v[24:27], v[132:147]
    v_exp_f32 v191, v191
    v_cvt_pk_bf16_f32 v20, v186, v187
    v_exp_f32 v192, v192
    v_cvt_pk_bf16_f32 v21, v188, v189
    v_exp_f32 v193, v193
    v_cvt_pk_bf16_f32 v22, v190, v191
    v_mfma_f32_32x32x16_bf16 v[100:115], v[28:31], v[12:15], v[164:179]
    v_exp_f32 v194, v194
    v_cvt_pk_bf16_f32 v23, v192, v193
    v_exp_f32 v195, v195
    v_exp_f32 v196, v196
    v_exp_f32 v197, v197
    v_mfma_f32_32x32x16_bf16 v[116:131], v[76:79], v[20:23], v[116:131]
    v_exp_f32 v198, v198
    v_exp_f32 v199, v199
    v_exp_f32 v200, v200
    v_exp_f32 v201, v201
    v_cvt_pk_bf16_f32 v24, v194, v195
    v_cvt_pk_bf16_f32 v25, v196, v197
    v_cvt_pk_bf16_f32 v26, v198, v199
    v_cvt_pk_bf16_f32 v27, v200, v201
    v_mfma_f32_32x32x4_2b_bf16 v[84:115], v[36:37], v[16:17], v[84:115] cbsz:1 abid:0
    v_exp_f32 v202, v202
    v_exp_f32 v203, v203
    v_exp_f32 v204, v204
    v_exp_f32 v205, v205
    v_exp_f32 v206, v206
    v_exp_f32 v207, v207
    v_exp_f32 v208, v208
    v_exp_f32 v209, v209
    v_exp_f32 v210, v210
    v_mfma_f32_32x32x16_bf16 v[116:131], v[80:83], v[24:27], v[116:131]
    v_cvt_pk_bf16_f32 v20, v202, v203
    v_cvt_pk_bf16_f32 v21, v204, v205
    v_cvt_pk_bf16_f32 v22, v206, v207
    v_cvt_pk_bf16_f32 v23, v208, v209
    v_exp_f32 v211, v211
    v_exp_f32 v212, v212
    v_exp_f32 v213, v213
    v_mfma_f32_32x32x16_bf16 v[132:147], v[76:79], v[20:23], v[132:147]
    v_exp_f32 v214, v214
    v_exp_f32 v215, v215
    v_exp_f32 v216, v216
    v_exp_f32 v217, v217
    v_cvt_pk_bf16_f32 v24, v210, v211
    v_cvt_pk_bf16_f32 v25, v212, v213
    v_cvt_pk_bf16_f32 v26, v214, v215
    v_cvt_pk_bf16_f32 v27, v216, v217
    v_mfma_f32_32x32x16_bf16 v[186:201], v[32:35], v[8:11], v[148:163]
    ds_read_b128 v[56:59], v1 offset:10496
    ds_read_b128 v[64:67], v2 offset:10496
    v_exp_f32 v84, v84
    v_exp_f32 v85, v85
    v_exp_f32 v86, v86
    v_exp_f32 v87, v87
    v_exp_f32 v88, v88
    v_mfma_f32_32x32x16_bf16 v[132:147], v[80:83], v[24:27], v[132:147]
    ds_read_b128 v[60:63], v1 offset:11520
    v_exp_f32 v89, v89
    v_cvt_pk_bf16_f32 v20, v84, v85
    v_exp_f32 v90, v90
    v_cvt_pk_bf16_f32 v21, v86, v87
    v_exp_f32 v91, v91
    v_cvt_pk_bf16_f32 v22, v88, v89
    v_mfma_f32_32x32x16_bf16 v[202:217], v[32:35], v[12:15], v[164:179]
    ds_read_b128 v[68:71], v3 offset:10496
    v_exp_f32 v92, v92
    v_cvt_pk_bf16_f32 v23, v90, v91
    v_exp_f32 v93, v93
    v_exp_f32 v94, v94
    v_exp_f32 v95, v95
    v_mfma_f32_32x32x16_bf16 v[116:131], v[40:43], v[20:23], v[116:131]
    ds_read_b128 v[72:75], v3 offset:11168
    v_exp_f32 v96, v96
    v_exp_f32 v97, v97
    v_exp_f32 v98, v98
    v_exp_f32 v99, v99
    v_cvt_pk_bf16_f32 v24, v92, v93
    v_cvt_pk_bf16_f32 v25, v94, v95
    v_cvt_pk_bf16_f32 v26, v96, v97
    v_cvt_pk_bf16_f32 v27, v98, v99
    v_mfma_f32_32x32x4_2b_bf16 v[186:217], v[38:39], v[16:17], v[186:217] cbsz:1 abid:0
    ds_read_b128 v[76:79], v3 offset:11840
    ds_read_b128 v[80:83], v3 offset:12512
    v_exp_f32 v100, v100
    v_exp_f32 v101, v101
    v_exp_f32 v102, v102
    v_exp_f32 v103, v103
    v_exp_f32 v104, v104
    v_exp_f32 v105, v105
    v_exp_f32 v106, v106
    v_exp_f32 v107, v107
    v_exp_f32 v108, v108
    v_mfma_f32_32x32x16_bf16 v[116:131], v[44:47], v[24:27], v[116:131]
    v_cvt_pk_bf16_f32 v20, v100, v101
    v_cvt_pk_bf16_f32 v21, v102, v103
    v_cvt_pk_bf16_f32 v22, v104, v105
    v_cvt_pk_bf16_f32 v23, v106, v107
    v_exp_f32 v109, v109
    v_exp_f32 v110, v110
    v_exp_f32 v111, v111
    v_mfma_f32_32x32x16_bf16 v[132:147], v[40:43], v[20:23], v[132:147]
    s_waitcnt lgkmcnt(0)
    v_exp_f32 v112, v112
    v_exp_f32 v113, v113
    v_exp_f32 v114, v114
    v_exp_f32 v115, v115
    v_cvt_pk_bf16_f32 v24, v108, v109
    v_cvt_pk_bf16_f32 v25, v110, v111
    v_cvt_pk_bf16_f32 v26, v112, v113
    v_cvt_pk_bf16_f32 v27, v114, v115
    v_mfma_f32_32x32x16_bf16 v[84:99], v[56:59], v[8:11], v[148:163]
    v_exp_f32 v186, v186
    v_exp_f32 v187, v187
    v_exp_f32 v188, v188
    v_exp_f32 v189, v189
    v_exp_f32 v190, v190
    v_mfma_f32_32x32x16_bf16 v[132:147], v[44:47], v[24:27], v[132:147]
    v_exp_f32 v191, v191
    v_cvt_pk_bf16_f32 v20, v186, v187
    v_exp_f32 v192, v192
    v_cvt_pk_bf16_f32 v21, v188, v189
    v_exp_f32 v193, v193
    v_cvt_pk_bf16_f32 v22, v190, v191
    v_mfma_f32_32x32x16_bf16 v[100:115], v[56:59], v[12:15], v[164:179]
    v_exp_f32 v194, v194
    v_cvt_pk_bf16_f32 v23, v192, v193
    v_exp_f32 v195, v195
    v_exp_f32 v196, v196
    v_exp_f32 v197, v197
    v_mfma_f32_32x32x16_bf16 v[116:131], v[48:51], v[20:23], v[116:131]
    v_exp_f32 v198, v198
    v_exp_f32 v199, v199
    v_exp_f32 v200, v200
    v_exp_f32 v201, v201
    v_cvt_pk_bf16_f32 v24, v194, v195
    v_cvt_pk_bf16_f32 v25, v196, v197
    v_cvt_pk_bf16_f32 v26, v198, v199
    v_cvt_pk_bf16_f32 v27, v200, v201
    v_mfma_f32_32x32x4_2b_bf16 v[84:115], v[64:65], v[16:17], v[84:115] cbsz:1 abid:0
    v_exp_f32 v202, v202
    v_exp_f32 v203, v203
    v_exp_f32 v204, v204
    v_exp_f32 v205, v205
    v_exp_f32 v206, v206
    v_exp_f32 v207, v207
    v_exp_f32 v208, v208
    v_exp_f32 v209, v209
    v_exp_f32 v210, v210
    v_mfma_f32_32x32x16_bf16 v[116:131], v[52:55], v[24:27], v[116:131]
    v_cvt_pk_bf16_f32 v20, v202, v203
    v_cvt_pk_bf16_f32 v21, v204, v205
    v_cvt_pk_bf16_f32 v22, v206, v207
    v_cvt_pk_bf16_f32 v23, v208, v209
    v_exp_f32 v211, v211
    v_exp_f32 v212, v212
    v_exp_f32 v213, v213
    v_mfma_f32_32x32x16_bf16 v[132:147], v[48:51], v[20:23], v[132:147]
    v_exp_f32 v214, v214
    v_exp_f32 v215, v215
    v_exp_f32 v216, v216
    v_exp_f32 v217, v217
    v_cvt_pk_bf16_f32 v24, v210, v211
    v_cvt_pk_bf16_f32 v25, v212, v213
    v_cvt_pk_bf16_f32 v26, v214, v215
    v_cvt_pk_bf16_f32 v27, v216, v217
    v_mfma_f32_32x32x16_bf16 v[186:201], v[60:63], v[8:11], v[148:163]
    ds_read_b128 v[28:31], v1 offset:15744
    ds_read_b128 v[36:39], v2 offset:15744
    v_exp_f32 v84, v84
    v_exp_f32 v85, v85
    v_exp_f32 v86, v86
    v_exp_f32 v87, v87
    v_exp_f32 v88, v88
    v_mfma_f32_32x32x16_bf16 v[132:147], v[52:55], v[24:27], v[132:147]
    ds_read_b128 v[32:35], v1 offset:16768
    v_exp_f32 v89, v89
    v_cvt_pk_bf16_f32 v20, v84, v85
    v_exp_f32 v90, v90
    v_cvt_pk_bf16_f32 v21, v86, v87
    v_exp_f32 v91, v91
    v_cvt_pk_bf16_f32 v22, v88, v89
    v_mfma_f32_32x32x16_bf16 v[202:217], v[60:63], v[12:15], v[164:179]
    ds_read_b128 v[40:43], v3 offset:15744
    v_exp_f32 v92, v92
    v_cvt_pk_bf16_f32 v23, v90, v91
    v_exp_f32 v93, v93
    v_exp_f32 v94, v94
    v_exp_f32 v95, v95
    v_mfma_f32_32x32x16_bf16 v[116:131], v[68:71], v[20:23], v[116:131]
    ds_read_b128 v[44:47], v3 offset:16416
    v_exp_f32 v96, v96
    v_exp_f32 v97, v97
    v_exp_f32 v98, v98
    v_exp_f32 v99, v99
    v_cvt_pk_bf16_f32 v24, v92, v93
    v_cvt_pk_bf16_f32 v25, v94, v95
    v_cvt_pk_bf16_f32 v26, v96, v97
    v_cvt_pk_bf16_f32 v27, v98, v99
    v_mfma_f32_32x32x4_2b_bf16 v[186:217], v[66:67], v[16:17], v[186:217] cbsz:1 abid:0
    ds_read_b128 v[48:51], v3 offset:17088
    ds_read_b128 v[52:55], v3 offset:17760
    v_exp_f32 v100, v100
    v_exp_f32 v101, v101
    v_exp_f32 v102, v102
    v_exp_f32 v103, v103
    v_exp_f32 v104, v104
    v_exp_f32 v105, v105
    v_exp_f32 v106, v106
    v_exp_f32 v107, v107
    v_exp_f32 v108, v108
    v_mfma_f32_32x32x16_bf16 v[116:131], v[72:75], v[24:27], v[116:131]
    v_cvt_pk_bf16_f32 v20, v100, v101
    v_cvt_pk_bf16_f32 v21, v102, v103
    v_cvt_pk_bf16_f32 v22, v104, v105
    v_cvt_pk_bf16_f32 v23, v106, v107
    v_exp_f32 v109, v109
    v_exp_f32 v110, v110
    v_exp_f32 v111, v111
    v_mfma_f32_32x32x16_bf16 v[132:147], v[68:71], v[20:23], v[132:147]
    s_waitcnt lgkmcnt(0)
    v_exp_f32 v112, v112
    v_exp_f32 v113, v113
    v_exp_f32 v114, v114
    v_exp_f32 v115, v115
    v_cvt_pk_bf16_f32 v24, v108, v109
    v_cvt_pk_bf16_f32 v25, v110, v111
    v_cvt_pk_bf16_f32 v26, v112, v113
    v_cvt_pk_bf16_f32 v27, v114, v115
    v_mfma_f32_32x32x16_bf16 v[84:99], v[28:31], v[8:11], v[148:163]
    v_exp_f32 v186, v186
    v_exp_f32 v187, v187
    v_exp_f32 v188, v188
    v_exp_f32 v189, v189
    v_exp_f32 v190, v190
    v_mfma_f32_32x32x16_bf16 v[132:147], v[72:75], v[24:27], v[132:147]
    v_exp_f32 v191, v191
    v_cvt_pk_bf16_f32 v20, v186, v187
    v_exp_f32 v192, v192
    v_cvt_pk_bf16_f32 v21, v188, v189
    v_exp_f32 v193, v193
    v_cvt_pk_bf16_f32 v22, v190, v191
    v_mfma_f32_32x32x16_bf16 v[100:115], v[28:31], v[12:15], v[164:179]
    v_exp_f32 v194, v194
    v_cvt_pk_bf16_f32 v23, v192, v193
    v_exp_f32 v195, v195
    v_exp_f32 v196, v196
    v_exp_f32 v197, v197
    v_mfma_f32_32x32x16_bf16 v[116:131], v[76:79], v[20:23], v[116:131]
    v_exp_f32 v198, v198
    v_exp_f32 v199, v199
    v_exp_f32 v200, v200
    v_exp_f32 v201, v201
    v_cvt_pk_bf16_f32 v24, v194, v195
    v_cvt_pk_bf16_f32 v25, v196, v197
    v_cvt_pk_bf16_f32 v26, v198, v199
    v_cvt_pk_bf16_f32 v27, v200, v201
    v_mfma_f32_32x32x4_2b_bf16 v[84:115], v[36:37], v[16:17], v[84:115] cbsz:1 abid:0
    v_exp_f32 v202, v202
    v_exp_f32 v203, v203
    v_exp_f32 v204, v204
    v_exp_f32 v205, v205
    v_exp_f32 v206, v206
    v_exp_f32 v207, v207
    v_exp_f32 v208, v208
    v_exp_f32 v209, v209
    v_exp_f32 v210, v210
    v_mfma_f32_32x32x16_bf16 v[116:131], v[80:83], v[24:27], v[116:131]
    v_add_u32 v1, 20992, v1
    v_add_u32 v2, 20992, v2
    v_add_u32 v3, 20992, v3
    v_cvt_pk_bf16_f32 v20, v202, v203
    v_cvt_pk_bf16_f32 v21, v204, v205
    v_cvt_pk_bf16_f32 v22, v206, v207
    v_cvt_pk_bf16_f32 v23, v208, v209
    v_exp_f32 v211, v211
    v_exp_f32 v212, v212
    v_exp_f32 v213, v213
    v_mfma_f32_32x32x16_bf16 v[132:147], v[76:79], v[20:23], v[132:147]
    v_exp_f32 v214, v214
    v_exp_f32 v215, v215
    v_exp_f32 v216, v216
    v_exp_f32 v217, v217
    v_cvt_pk_bf16_f32 v24, v210, v211
    v_cvt_pk_bf16_f32 v25, v212, v213
    v_cvt_pk_bf16_f32 v26, v214, v215
    v_cvt_pk_bf16_f32 v27, v216, v217
    s_add_u32 s20, s20, 1
    s_cmp_lt_u32 s20, s21
    s_cbranch_scc1 K2_NOBAR
    s_cmp_lt_i32 s20, 0
    s_cbranch_scc1 K2_BAR
KT_B0:
    v_mfma_f32_32x32x16_bf16 v[132:147], v[80:83], v[24:27], v[132:147]
    v_mov_b32 v84, v124
    v_mov_b32 v85, v124
    v_add_f32 v86, |v116|, |v117|
    v_add_f32 v87, |v118|, |v119|
    v_permlane32_swap_b32 v84, v85
    v_add_f32 v86, v86, |v120|
    v_add_f32 v87, v87, |v121|
    v_rcp_f32 v84, v85
    v_add_f32 v86, v86, |v122|
    v_add_f32 v87, v87, |v123|
    v_add_f32 v86, v86, |v124|
    s_mov_b32 exec_hi, 0
    v_add_f32 v87, v87, |v125|
    v_add_f32 v86, v86, |v126|
    v_add_f32 v87, v87, |v127|
    s_mov_b32 exec_hi, -1
    v_add_f32 v86, v86, v87
    v_pk_mul_f32 v[116:117], v[116:117], v[84:85] op_sel:[0,0] op_sel_hi:[1,0]
    v_pk_mul_f32 v[118:119], v[118:119], v[84:85] op_sel:[0,0] op_sel_hi:[1,0]
    v_pk_mul_f32 v[120:121], v[120:121], v[84:85] op_sel:[0,0] op_sel_hi:[1,0]
    v_pk_mul_f32 v[122:123], v[122:123], v[84:85] op_sel:[0,0] op_sel_hi:[1,0]
    v_pk_mul_f32 v[124:125], v[124:125], v[84:85] op_sel:[0,0] op_sel_hi:[1,0]
    v_pk_mul_f32 v[126:127], v[126:127], v[84:85] op_sel:[0,0] op_sel_hi:[1,0]
    v_cvt_pk_bf16_f32 v116, v116, v117
    v_cvt_pk_bf16_f32 v117, v118, v119
    v_cvt_pk_bf16_f32 v118, v120, v121
    v_cvt_pk_bf16_f32 v119, v122, v123
    v_cvt_pk_bf16_f32 v20, v124, v125
    v_cvt_pk_bf16_f32 v21, v126, v127
    v_mov_b32 v100, v140
    v_mov_b32 v101, v140
    v_add_f32 v102, |v132|, |v133|
    v_add_f32 v103, |v134|, |v135|
    v_permlane32_swap_b32 v100, v101
    v_add_f32 v102, v102, |v136|
    v_add_f32 v103, v103, |v137|
    v_rcp_f32 v100, v101
    v_add_f32 v102, v102, |v138|
    v_add_f32 v103, v103, |v139|
    v_add_f32 v102, v102, |v140|
    s_mov_b32 exec_hi, 0
    v_add_f32 v103, v103, |v141|
    v_add_f32 v102, v102, |v142|
    v_add_f32 v103, v103, |v143|
    s_mov_b32 exec_hi, -1
    v_add_f32 v102, v102, v103
    v_pk_mul_f32 v[132:133], v[132:133], v[100:101] op_sel:[0,0] op_sel_hi:[1,0]
    v_pk_mul_f32 v[134:135], v[134:135], v[100:101] op_sel:[0,0] op_sel_hi:[1,0]
    v_pk_mul_f32 v[136:137], v[136:137], v[100:101] op_sel:[0,0] op_sel_hi:[1,0]
    v_pk_mul_f32 v[138:139], v[138:139], v[100:101] op_sel:[0,0] op_sel_hi:[1,0]
    v_pk_mul_f32 v[140:141], v[140:141], v[100:101] op_sel:[0,0] op_sel_hi:[1,0]
    v_pk_mul_f32 v[142:143], v[142:143], v[100:101] op_sel:[0,0] op_sel_hi:[1,0]
    v_cvt_pk_bf16_f32 v132, v132, v133
    v_cvt_pk_bf16_f32 v133, v134, v135
    v_cvt_pk_bf16_f32 v134, v136, v137
    v_cvt_pk_bf16_f32 v135, v138, v139
    v_cvt_pk_bf16_f32 v22, v140, v141
    v_cvt_pk_bf16_f32 v23, v142, v143
    v_add_f32 v182, v86, v102
    s_mov_b32 s18, 0x7b800000
    v_cmp_ngt_f32 vcc, s18, v182
    s_nop 4
    s_cbranch_vccnz K2_REDO
K2_STORE:
    s_bitcmp1_b32 s12, 4
    s_cbranch_scc0 K2_ST2
    v_swap_b32 v20, v22
    v_swap_b32 v21, v23
K2_ST2:
    buffer_store_dwordx4 v[116:119], v180, s[8:11], s24 offen sc1
    buffer_store_dwordx4 v[132:135], v180, s[8:11], s25 offen sc1
    buffer_store_dwordx4 v[20:23], v181, s[8:11], s27 offen sc1
    s_barrier
    s_load_dwordx2 s[34:35], s[0:1], 64
    v_mov_b32 v8, 0
    v_mov_b32 v9, 0
    v_mov_b32 v10, 0
    v_mov_b32 v11, 0
    ds_write_b128 v8, v[8:11] offset:61440
    s_waitcnt lgkmcnt(0)
    s_barrier
    s_barrier
    s_barrier
    v_mov_b32 v7, 0
    v_lshrrev_b32 v1, 1, v0
    v_lshlrev_b32 v6, 4, v0
    v_add_u32 v6, 65536, v6
    s_cmp_ge_u32 s6, 27
    s_cbranch_scc1 KT_C
    ds_read_b128 v[44:47], v6 offset:0
    ds_read_b128 v[52:55], v6 offset:4096
    ds_read_b128 v[60:63], v6 offset:8192
    ds_read_b128 v[68:71], v6 offset:12288
    ds_read_b128 v[76:79], v6 offset:16384
    s_mul_i32 s24, s3, 27
    s_add_u32 s24, s24, s6
    v_mul_u32_u24 v2, 5, v1
    v_and_b32 v3, 1, v2
    v_lshlrev_b32 v3, 4, v3
    v_lshrrev_b32 v2, 1, v2
    v_lshlrev_b32 v2, 3, v2
    v_bfe_u32 v5, v0, 4, 2
    v_lshrrev_b32 v6, 1, v5
    v_lshlrev_b32 v5, 1, v5
    v_and_b32 v5, 2, v5
    v_lshl_or_b32 v5, v6, 2, v5
    v_and_b32 v6, 1, v0
    v_lshl_add_u32 v5, v6, 3, v5
    s_lshl_b32 s25, s14, 6
    v_lshl_add_u32 v1, v5, 2, s25
    s_lshl_b32 s24, s24, 7
    s_add_u32 s24, s24, 14702592
    s_waitcnt lgkmcnt(4)
    v_lshlrev_b32 v40, 16, v44
    v_and_b32 v41, 0xffff0000, v44
    v_lshlrev_b32 v42, 16, v45
    v_and_b32 v43, 0xffff0000, v45
    v_lshlrev_b32 v44, 16, v46
    v_and_b32 v45, 0xffff0000, v46
    v_lshlrev_b32 v46, 16, v47
    v_and_b32 v47, 0xffff0000, v47
    s_waitcnt lgkmcnt(3)
    v_lshlrev_b32 v48, 16, v52
    v_and_b32 v49, 0xffff0000, v52
    v_lshlrev_b32 v50, 16, v53
    v_and_b32 v51, 0xffff0000, v53
    v_lshlrev_b32 v52, 16, v54
    v_and_b32 v53, 0xffff0000, v54
    v_lshlrev_b32 v54, 16, v55
    v_and_b32 v55, 0xffff0000, v55
    s_waitcnt lgkmcnt(2)
    v_lshlrev_b32 v56, 16, v60
    v_and_b32 v57, 0xffff0000, v60
    v_lshlrev_b32 v58, 16, v61
    v_and_b32 v59, 0xffff0000, v61
    v_lshlrev_b32 v60, 16, v62
    v_and_b32 v61, 0xffff0000, v62
    v_lshlrev_b32 v62, 16, v63
    v_and_b32 v63, 0xffff0000, v63
    s_waitcnt lgkmcnt(1)
    v_lshlrev_b32 v64, 16, v68
    v_and_b32 v65, 0xffff0000, v68
    v_lshlrev_b32 v66, 16, v69
    v_and_b32 v67, 0xffff0000, v69
    v_lshlrev_b32 v68, 16, v70
    v_and_b32 v69, 0xffff0000, v70
    v_lshlrev_b32 v70, 16, v71
    v_and_b32 v71, 0xffff0000, v71
    s_waitcnt lgkmcnt(0)
    v_lshlrev_b32 v72, 16, v76
    v_and_b32 v73, 0xffff0000, v76
    v_lshlrev_b32 v74, 16, v77
    v_and_b32 v75, 0xffff0000, v77
    v_lshlrev_b32 v76, 16, v78
    v_and_b32 v77, 0xffff0000, v78
    v_lshlrev_b32 v78, 16, v79
    v_and_b32 v79, 0xffff0000, v79
    s_barrier
    s_cmp_lg_u32 s14, 0
    s_cbranch_scc1 KT_PKX
    s_mov_b32 s25, 14583808
    v_and_b32 v12, 31, v0
    v_lshlrev_b32 v12, 7, v12
    s_mov_b32 s48, 262144
    s_sleep 8
KT_PK:
KT_PK0:
    buffer_load_dwordx4 v[8:11], v12, s[8:11], s25 offen sc1
KT_PK1:
    s_waitcnt vmcnt(0)
    v_cmp_ne_u32 vcc, s33, v11
    s_cbranch_vccz KT_PK2
    s_sub_u32 s48, s48, 1
    s_cbranch_scc0 KT_PK
KT_PK2:
    v_max_i32_dpp v5, v8, v8 quad_perm:[1,0,3,2] row_mask:0xf bank_mask:0xf
    s_nop 1
    v_max_i32_dpp v5, v5, v5 quad_perm:[2,3,0,1] row_mask:0xf bank_mask:0xf
    s_nop 1
    v_max_i32_dpp v5, v5, v5 row_half_mirror row_mask:0xf bank_mask:0xf
    s_nop 1
    v_max_i32_dpp v5, v5, v5 row_mirror row_mask:0xf bank_mask:0xf
    s_nop 1
    v_mov_b32 v6, v5
    s_nop 1
    v_permlane16_swap_b32 v5, v6
    v_max_i32 v5, v5, v6
    v_mov_b32 v11, s33
    v_cmp_eq_u32 vcc, v5, v8
    s_nop 3
    s_mov_b64 exec, vcc
    ds_write_b128 v7, v[8:11] offset:61440
    s_mov_b64 exec, -1
KT_PKX:
    s_mov_b32 s48, 262144
KT_PB:
    ds_read_b128 v[8:11], v7 offset:61440
    s_waitcnt lgkmcnt(0)
    v_readfirstlane_b32 s26, v11
    v_readfirstlane_b32 s27, v8
    s_cmp_eq_u32 s26, s33
    s_cbranch_scc1 KT_PB2
    s_sleep 1
    s_sub_u32 s48, s48, 1
    s_cbranch_scc0 KT_PB
KT_PB2:
    s_and_b32 s27, s27, 0x7ff
    s_lshr_b32 s25, s27, 6
    s_mul_i32 s25, s25, 2560
    s_add_u32 s25, s25, 14620672
    buffer_load_dwordx4 v[24:27], v2, s[8:11], s25 offen sc1
    buffer_load_dwordx2 v[28:29], v2, s[8:11], s25 offen offset:16 sc1
    v_mul_f32 v8, -v9, v10
    s_mov_b32 s48, 262144
    s_branch KT_PC1
KT_PC:
KT_PC0:
    buffer_load_dwordx4 v[24:27], v2, s[8:11], s25 offen sc1
    buffer_load_dwordx2 v[28:29], v2, s[8:11], s25 offen offset:16 sc1
KT_PC1:
    s_waitcnt vmcnt(0)
    v_cmp_ne_u32 vcc, s33, v25
    v_cmp_ne_u32 s[50:51], s33, v27
    s_or_b64 vcc, vcc, s[50:51]
    v_cmp_ne_u32 s[52:53], s33, v29
    s_or_b64 vcc, vcc, s[52:53]
    s_cbranch_vccz KT_PC2
    s_sub_u32 s48, s48, 1
    s_cbranch_scc0 KT_PC
KT_PC2:
    v_alignbit_b32 v24, v26, v24, v3
    v_alignbit_b32 v26, v28, v26, v3
    v_lshrrev_b32 v28, v3, v28
    v_and_b32 v25, 0xffff0000, v24
    v_lshlrev_b32 v24, 16, v24
    v_and_b32 v27, 0xffff0000, v26
    v_lshlrev_b32 v26, 16, v26
    v_lshlrev_b32 v28, 16, v28
    v_fma_f32 v24, v24, v10, v8
    v_fma_f32 v25, v25, v10, v8
    v_fma_f32 v26, v26, v10, v8
    v_fma_f32 v27, v27, v10, v8
    v_fma_f32 v28, v28, v10, v8
    v_cvt_pk_bf16_f32 v24, v24, v25
    v_cvt_pk_bf16_f32 v26, v26, v27
    v_cvt_pk_bf16_f32 v28, v28, v28
    v_and_b32 v25, 0xffff0000, v24
    v_lshlrev_b32 v24, 16, v24
    v_and_b32 v27, 0xffff0000, v26
    v_lshlrev_b32 v26, 16, v26
    v_lshlrev_b32 v28, 16, v28
    v_pk_mul_f32 v[16:17], v[40:41], v[24:25] op_sel:[0,0] op_sel_hi:[1,0]
    v_pk_mul_f32 v[18:19], v[42:43], v[24:25] op_sel:[0,0] op_sel_hi:[1,0]
    v_pk_mul_f32 v[20:21], v[44:45], v[24:25] op_sel:[0,0] op_sel_hi:[1,0]
    v_pk_mul_f32 v[22:23], v[46:47], v[24:25] op_sel:[0,0] op_sel_hi:[1,0]
    v_pk_fma_f32 v[16:17], v[48:49], v[24:25], v[16:17] op_sel:[0,1,0] op_sel_hi:[1,1,1]
    v_pk_fma_f32 v[18:19], v[50:51], v[24:25], v[18:19] op_sel:[0,1,0] op_sel_hi:[1,1,1]
    v_pk_fma_f32 v[20:21], v[52:53], v[24:25], v[20:21] op_sel:[0,1,0] op_sel_hi:[1,1,1]
    v_pk_fma_f32 v[22:23], v[54:55], v[24:25], v[22:23] op_sel:[0,1,0] op_sel_hi:[1,1,1]
    v_pk_fma_f32 v[16:17], v[56:57], v[26:27], v[16:17] op_sel:[0,0,0] op_sel_hi:[1,0,1]
    v_pk_fma_f32 v[18:19], v[58:59], v[26:27], v[18:19] op_sel:[0,0,0] op_sel_hi:[1,0,1]
    v_pk_fma_f32 v[20:21], v[60:61], v[26:27], v[20:21] op_sel:[0,0,0] op_sel_hi:[1,0,1]
    v_pk_fma_f32 v[22:23], v[62:63], v[26:27], v[22:23] op_sel:[0,0,0] op_sel_hi:[1,0,1]
    v_pk_fma_f32 v[16:17], v[64:65], v[26:27], v[16:17] op_sel:[0,1,0] op_sel_hi:[1,1,1]
    v_pk_fma_f32 v[18:19], v[66:67], v[26:27], v[18:19] op_sel:[0,1,0] op_sel_hi:[1,1,1]
    v_pk_fma_f32 v[20:21], v[68:69], v[26:27], v[20:21] op_sel:[0,1,0] op_sel_hi:[1,1,1]
    v_pk_fma_f32 v[22:23], v[70:71], v[26:27], v[22:23] op_sel:[0,1,0] op_sel_hi:[1,1,1]
    v_pk_fma_f32 v[16:17], v[72:73], v[28:29], v[16:17] op_sel:[0,0,0] op_sel_hi:[1,0,1]
    v_pk_fma_f32 v[18:19], v[74:75], v[28:29], v[18:19] op_sel:[0,0,0] op_sel_hi:[1,0,1]
    v_pk_fma_f32 v[20:21], v[76:77], v[28:29], v[20:21] op_sel:[0,0,0] op_sel_hi:[1,0,1]
    v_pk_fma_f32 v[22:23], v[78:79], v[28:29], v[22:23] op_sel:[0,0,0] op_sel_hi:[1,0,1]
    s_nop 1
    v_permlane32_swap_b32 v16, v20
    v_permlane32_swap_b32 v17, v21
    v_permlane32_swap_b32 v18, v22
    v_permlane32_swap_b32 v19, v23
    v_add_f32 v16, v16, v20
    v_add_f32 v17, v17, v21
    v_add_f32 v18, v18, v22
    v_add_f32 v19, v19, v23
    s_nop 0
    v_permlane16_swap_b32 v16, v18
    v_permlane16_swap_b32 v17, v19
    v_add_f32 v16, v16, v18
    v_add_f32 v17, v17, v19
    s_nop 0
    v_add_f32_dpp v16, v16, v16 row_ror:8 row_mask:0xf bank_mask:0xf
    v_add_f32_dpp v17, v17, v17 row_ror:8 row_mask:0xf bank_mask:0xf
    s_nop 0
    v_add_f32_dpp v16, v16, v16 row_ror:4 row_mask:0xf bank_mask:0xf
    v_add_f32_dpp v17, v17, v17 row_ror:4 row_mask:0xf bank_mask:0xf
    s_nop 0
    v_add_f32_dpp v16, v16, v16 row_ror:2 row_mask:0xf bank_mask:0xf
    v_add_f32_dpp v17, v17, v17 row_ror:2 row_mask:0xf bank_mask:0xf
    ds_write_b64 v1, v[16:17] offset:61504
    v_lshlrev_b32 v1, 2, v0
    v_and_b32 v2, 0x39, v0
    v_min_u32 v2, 1, v2
    v_lshl_or_b32 v2, v2, 31, v1
    s_waitcnt lgkmcnt(0)
    s_barrier
    s_cmp_lg_u32 s14, 0
    s_cbranch_scc1 KT_END
    v_add_u32 v1, 61504, v1
    ds_read2_b32 v[8:9], v1 offset0:0 offset1:16
    ds_read2_b32 v[10:11], v1 offset0:32 offset1:48
    v_mov_b32 v13, s33
    s_waitcnt lgkmcnt(0)
    v_pk_add_f32 v[8:9], v[8:9], v[10:11]
    v_add_f32 v8, v8, v9
    v_cvt_pk_bf16_f32 v8, v8, v8
    v_and_b32 v8, 0xffff0000, v8
    v_mul_f32 v10, 0xbfb8aa3b, v8
    v_exp_f32 v10, v10
    v_mov_b32_dpp v9, v8 row_ror:8 row_mask:0xf bank_mask:0xf
    v_add_f32 v10, 1.0, v10
    v_rcp_f32 v10, v10
    s_nop 0
    v_mul_f32 v8, v8, v10
    v_cvt_pk_bf16_f32 v8, v8, v8
    v_and_b32 v8, 0xffff0000, v8
    v_mul_f32 v8, v8, v9
    s_nop 1
    v_mov_b32_dpp v9, v8 quad_perm:[1,1,3,3] row_mask:0xf bank_mask:0xf
    v_cvt_pk_bf16_f32 v12, v8, v9
    buffer_store_dwordx2 v[12:13], v2, s[8:11], s24 offen sc1
    s_endpgm
KT_C:
    ds_read_b128 v[44:47], v6 offset:0
    ds_read_b128 v[52:55], v6 offset:4096
    ds_read_b128 v[60:63], v6 offset:8192
    ds_read_b128 v[68:71], v6 offset:12288
    ds_read_b128 v[76:79], v6 offset:16384
    ds_read_b128 v[84:87], v6 offset:20480
    ds_read_b128 v[92:95], v6 offset:24576
    ds_read_b128 v[100:103], v6 offset:28672
    ds_read_b128 v[108:111], v6 offset:32768
    ds_read_b128 v[116:119], v6 offset:36864
    ds_read_b128 v[124:127], v6 offset:40960
    ds_read_b128 v[132:135], v6 offset:45056
    ds_read_b128 v[140:143], v6 offset:49152
    ds_read_b128 v[148:151], v6 offset:53248
    ds_read_b128 v[156:159], v6 offset:57344
    ds_read_b128 v[164:167], v6 offset:61440
    s_mov_b32 s40, s34
    s_mov_b32 s41, s35
    s_mov_b32 s42, 0x280000
    s_mov_b32 s43, 0x00020000
    s_mul_i32 s24, s3, 5
    s_add_u32 s24, s24, s6
    s_sub_u32 s24, s24, 27
    s_lshl_b32 s24, s24, 5
    v_and_b32 v3, 1, v0
    v_min_u32 v2, 107, v1
    v_lshlrev_b32 v2, 8, v2
    v_bfe_u32 v5, v0, 4, 2
    v_lshrrev_b32 v6, 1, v5
    v_lshlrev_b32 v5, 1, v5
    v_and_b32 v5, 2, v5
    v_lshl_or_b32 v5, v6, 2, v5
    v_lshl_add_u32 v5, v3, 3, v5
    s_lshl_b32 s25, s14, 6
    v_lshl_add_u32 v1, v5, 2, s25
    v_and_b32 v3, 14, v0
    v_lshlrev_b32 v3, 2, v3
    s_lshl_b32 s28, s24, 1
    s_waitcnt lgkmcnt(15)
    v_lshlrev_b32 v40, 16, v44
    v_and_b32 v41, 0xffff0000, v44
    v_lshlrev_b32 v42, 16, v45
    v_and_b32 v43, 0xffff0000, v45
    v_lshlrev_b32 v44, 16, v46
    v_and_b32 v45, 0xffff0000, v46
    v_lshlrev_b32 v46, 16, v47
    v_and_b32 v47, 0xffff0000, v47
    s_waitcnt lgkmcnt(14)
    v_lshlrev_b32 v48, 16, v52
    v_and_b32 v49, 0xffff0000, v52
    v_lshlrev_b32 v50, 16, v53
    v_and_b32 v51, 0xffff0000, v53
    v_lshlrev_b32 v52, 16, v54
    v_and_b32 v53, 0xffff0000, v54
    v_lshlrev_b32 v54, 16, v55
    v_and_b32 v55, 0xffff0000, v55
    s_waitcnt lgkmcnt(13)
    v_lshlrev_b32 v56, 16, v60
    v_and_b32 v57, 0xffff0000, v60
    v_lshlrev_b32 v58, 16, v61
    v_and_b32 v59, 0xffff0000, v61
    v_lshlrev_b32 v60, 16, v62
    v_and_b32 v61, 0xffff0000, v62
    v_lshlrev_b32 v62, 16, v63
    v_and_b32 v63, 0xffff0000, v63
    s_waitcnt lgkmcnt(12)
    v_lshlrev_b32 v64, 16, v68
    v_and_b32 v65, 0xffff0000, v68
    v_lshlrev_b32 v66, 16, v69
    v_and_b32 v67, 0xffff0000, v69
    v_lshlrev_b32 v68, 16, v70
    v_and_b32 v69, 0xffff0000, v70
    v_lshlrev_b32 v70, 16, v71
    v_and_b32 v71, 0xffff0000, v71
    s_waitcnt lgkmcnt(11)
    v_lshlrev_b32 v72, 16, v76
    v_and_b32 v73, 0xffff0000, v76
    v_lshlrev_b32 v74, 16, v77
    v_and_b32 v75, 0xffff0000, v77
    v_lshlrev_b32 v76, 16, v78
    v_and_b32 v77, 0xffff0000, v78
    v_lshlrev_b32 v78, 16, v79
    v_and_b32 v79, 0xffff0000, v79
    s_waitcnt lgkmcnt(10)
    v_lshlrev_b32 v80, 16, v84
    v_and_b32 v81, 0xffff0000, v84
    v_lshlrev_b32 v82, 16, v85
    v_and_b32 v83, 0xffff0000, v85
    v_lshlrev_b32 v84, 16, v86
    v_and_b32 v85, 0xffff0000, v86
    v_lshlrev_b32 v86, 16, v87
    v_and_b32 v87, 0xffff0000, v87
    s_waitcnt lgkmcnt(9)
    v_lshlrev_b32 v88, 16, v92
    v_and_b32 v89, 0xffff0000, v92
    v_lshlrev_b32 v90, 16, v93
    v_and_b32 v91, 0xffff0000, v93
    v_lshlrev_b32 v92, 16, v94
    v_and_b32 v93, 0xffff0000, v94
    v_lshlrev_b32 v94, 16, v95
    v_and_b32 v95, 0xffff0000, v95
    s_waitcnt lgkmcnt(8)
    v_lshlrev_b32 v96, 16, v100
    v_and_b32 v97, 0xffff0000, v100
    v_lshlrev_b32 v98, 16, v101
    v_and_b32 v99, 0xffff0000, v101
    v_lshlrev_b32 v100, 16, v102
    v_and_b32 v101, 0xffff0000, v102
    v_lshlrev_b32 v102, 16, v103
    v_and_b32 v103, 0xffff0000, v103
    s_waitcnt lgkmcnt(7)
    v_lshlrev_b32 v104, 16, v108
    v_and_b32 v105, 0xffff0000, v108
    v_lshlrev_b32 v106, 16, v109
    v_and_b32 v107, 0xffff0000, v109
    v_lshlrev_b32 v108, 16, v110
    v_and_b32 v109, 0xffff0000, v110
    v_lshlrev_b32 v110, 16, v111
    v_and_b32 v111, 0xffff0000, v111
    s_waitcnt lgkmcnt(6)
    v_lshlrev_b32 v112, 16, v116
    v_and_b32 v113, 0xffff0000, v116
    v_lshlrev_b32 v114, 16, v117
    v_and_b32 v115, 0xffff0000, v117
    v_lshlrev_b32 v116, 16, v118
    v_and_b32 v117, 0xffff0000, v118
    v_lshlrev_b32 v118, 16, v119
    v_and_b32 v119, 0xffff0000, v119
    s_waitcnt lgkmcnt(5)
    v_lshlrev_b32 v120, 16, v124
    v_and_b32 v121, 0xffff0000, v124
    v_lshlrev_b32 v122, 16, v125
    v_and_b32 v123, 0xffff0000, v125
    v_lshlrev_b32 v124, 16, v126
    v_and_b32 v125, 0xffff0000, v126
    v_lshlrev_b32 v126, 16, v127
    v_and_b32 v127, 0xffff0000, v127
    s_waitcnt lgkmcnt(4)
    v_lshlrev_b32 v128, 16, v132
    v_and_b32 v129, 0xffff0000, v132
    v_lshlrev_b32 v130, 16, v133
    v_and_b32 v131, 0xffff0000, v133
    v_lshlrev_b32 v132, 16, v134
    v_and_b32 v133, 0xffff0000, v134
    v_lshlrev_b32 v134, 16, v135
    v_and_b32 v135, 0xffff0000, v135
    s_waitcnt lgkmcnt(3)
    v_lshlrev_b32 v136, 16, v140
    v_and_b32 v137, 0xffff0000, v140
    v_lshlrev_b32 v138, 16, v141
    v_and_b32 v139, 0xffff0000, v141
    v_lshlrev_b32 v140, 16, v142
    v_and_b32 v141, 0xffff0000, v142
    v_lshlrev_b32 v142, 16, v143
    v_and_b32 v143, 0xffff0000, v143
    s_waitcnt lgkmcnt(2)
    v_lshlrev_b32 v144, 16, v148
    v_and_b32 v145, 0xffff0000, v148
    v_lshlrev_b32 v146, 16, v149
    v_and_b32 v147, 0xffff0000, v149
    v_lshlrev_b32 v148, 16, v150
    v_and_b32 v149, 0xffff0000, v150
    v_lshlrev_b32 v150, 16, v151
    v_and_b32 v151, 0xffff0000, v151
    s_waitcnt lgkmcnt(1)
    v_lshlrev_b32 v152, 16, v156
    v_and_b32 v153, 0xffff0000, v156
    v_lshlrev_b32 v154, 16, v157
    v_and_b32 v155, 0xffff0000, v157
    v_lshlrev_b32 v156, 16, v158
    v_and_b32 v157, 0xffff0000, v158
    v_lshlrev_b32 v158, 16, v159
    v_and_b32 v159, 0xffff0000, v159
    s_waitcnt lgkmcnt(0)
    v_lshlrev_b32 v160, 16, v164
    v_and_b32 v161, 0xffff0000, v164
    v_lshlrev_b32 v162, 16, v165
    v_and_b32 v163, 0xffff0000, v165
    v_lshlrev_b32 v164, 16, v166
    v_and_b32 v165, 0xffff0000, v166
    v_lshlrev_b32 v166, 16, v167
    v_and_b32 v167, 0xffff0000, v167
    s_barrier
    s_cmp_lg_u32 s14, 0
    s_cbranch_scc1 KT_CKX
    s_mov_b32 s25, 14583808
    v_and_b32 v12, 31, v0
    v_lshlrev_b32 v12, 7, v12
    s_mov_b32 s48, 262144
    s_sleep 8
KT_CK:
KT_CK0:
    buffer_load_dwordx4 v[8:11], v12, s[8:11], s25 offen sc1
KT_CK1:
    s_waitcnt vmcnt(0)
    v_cmp_ne_u32 vcc, s33, v11
    s_cbranch_vccz KT_CK2
    s_sub_u32 s48, s48, 1
    s_cbranch_scc0 KT_CK
KT_CK2:
    v_max_i32_dpp v5, v8, v8 quad_perm:[1,0,3,2] row_mask:0xf bank_mask:0xf
    s_nop 1
    v_max_i32_dpp v5, v5, v5 quad_perm:[2,3,0,1] row_mask:0xf bank_mask:0xf
    s_nop 1
    v_max_i32_dpp v5, v5, v5 row_half_mirror row_mask:0xf bank_mask:0xf
    s_nop 1
    v_max_i32_dpp v5, v5, v5 row_mirror row_mask:0xf bank_mask:0xf
    s_nop 1
    v_mov_b32 v6, v5
    s_nop 1
    v_permlane16_swap_b32 v5, v6
    v_max_i32 v5, v5, v6
    v_mov_b32 v11, s33
    v_cmp_eq_u32 vcc, v5, v8
    s_nop 3
    s_mov_b64 exec, vcc
    ds_write_b128 v7, v[8:11] offset:61440
    s_mov_b64 exec, -1
KT_CKX:
    s_mov_b32 s48, 262144
KT_CB:
    ds_read_b128 v[8:11], v7 offset:61440
    s_waitcnt lgkmcnt(0)
    v_readfirstlane_b32 s26, v11
    v_readfirstlane_b32 s27, v8
    s_cmp_eq_u32 s26, s33
    s_cbranch_scc1 KT_CB2
    s_sleep 1
    s_sub_u32 s48, s48, 1
    s_cbranch_scc0 KT_CB
KT_CB2:
    s_and_b32 s27, s27, 0x7ff
    s_lshr_b32 s25, s27, 6
    s_mul_i32 s25, s25, 2560
    s_add_u32 s25, s25, s28
    s_add_u32 s25, s25, 14620672
    s_mul_i32 s22, s27, 1280
    s_add_u32 s22, s22, s24
    buffer_load_dwordx2 v[12:13], v3, s[8:11], s25 offen sc1
    v_ashrrev_i32 v5, 31, v8
    v_lshrrev_b32 v5, 1, v5
    v_xor_b32 v8, v8, v5
    v_cvt_pk_bf16_f32 v8, v8, v8
    v_and_b32 v8, 0xffff0000, v8
    v_mul_f32 v8, 0xbfb8aa3b, v8
    v_exp_f32 v8, v8
    v_and_b32 v5, 1, v0
    v_add_f32 v8, 1.0, v8
    v_rcp_f32 v8, v8
    v_lshlrev_b32 v5, 4, v5
    v_cvt_pk_bf16_f32 v8, v8, v8
    v_and_b32 v8, 0xffff0000, v8
    s_mov_b32 s48, 262144
    s_branch KT_CC1
KT_CC:
KT_CC0:
    buffer_load_dwordx2 v[12:13], v3, s[8:11], s25 offen sc1
KT_CC1:
    s_waitcnt vmcnt(0)
    v_cmp_ne_u32 vcc, s33, v13
    s_cbranch_vccz KT_CC2
    s_sub_u32 s48, s48, 1
    s_cbranch_scc0 KT_CC
KT_CC2:
    v_lshrrev_b32 v12, v5, v12
    v_lshlrev_b32 v12, 16, v12
    v_sub_f32 v9, v12, v9
    v_mul_f32 v9, v9, v10
    s_mov_b32 s25, 14702592
    v_cvt_pk_bf16_f32 v9, v9, v9
    v_and_b32 v9, 0xffff0000, v9
    s_mov_b32 s48, 262144
    s_sleep 24
KT_CA:
KT_CA0:
    buffer_load_dwordx4 v[24:27], v2, s[8:11], s25 offen offset:0 sc1
    buffer_load_dwordx4 v[28:31], v2, s[8:11], s25 offen offset:16 sc1
    buffer_load_dwordx4 v[32:35], v2, s[8:11], s25 offen offset:128 sc1
    buffer_load_dwordx4 v[36:39], v2, s[8:11], s25 offen offset:144 sc1
KT_CA1:
    s_waitcnt vmcnt(0)
    v_cmp_ne_u32 vcc, s33, v25
    v_cmp_ne_u32 s[50:51], s33, v27
    s_or_b64 vcc, vcc, s[50:51]
    v_cmp_ne_u32 s[52:53], s33, v29
    s_or_b64 vcc, vcc, s[52:53]
    v_cmp_ne_u32 s[50:51], s33, v31
    s_or_b64 vcc, vcc, s[50:51]
    v_cmp_ne_u32 s[52:53], s33, v33
    s_or_b64 vcc, vcc, s[52:53]
    v_cmp_ne_u32 s[50:51], s33, v35
    s_or_b64 vcc, vcc, s[50:51]
    v_cmp_ne_u32 s[52:53], s33, v37
    s_or_b64 vcc, vcc, s[52:53]
    v_cmp_ne_u32 s[50:51], s33, v39
    s_or_b64 vcc, vcc, s[50:51]
    s_cbranch_vccz KT_CA2
    s_sub_u32 s48, s48, 1
    s_cbranch_scc0 KT_CA
KT_CA2:
    v_and_b32 v25, 0xffff0000, v24
    v_lshlrev_b32 v24, 16, v24
    v_and_b32 v27, 0xffff0000, v26
    v_lshlrev_b32 v26, 16, v26
    v_and_b32 v29, 0xffff0000, v28
    v_lshlrev_b32 v28, 16, v28
    v_and_b32 v31, 0xffff0000, v30
    v_lshlrev_b32 v30, 16, v30
    v_and_b32 v33, 0xffff0000, v32
    v_lshlrev_b32 v32, 16, v32
    v_and_b32 v35, 0xffff0000, v34
    v_lshlrev_b32 v34, 16, v34
    v_and_b32 v37, 0xffff0000, v36
    v_lshlrev_b32 v36, 16, v36
    v_and_b32 v39, 0xffff0000, v38
    v_lshlrev_b32 v38, 16, v38
    v_pk_mul_f32 v[16:17], v[40:41], v[24:25] op_sel:[0,0] op_sel_hi:[1,0]
    v_pk_mul_f32 v[18:19], v[42:43], v[24:25] op_sel:[0,0] op_sel_hi:[1,0]
    v_pk_mul_f32 v[20:21], v[44:45], v[24:25] op_sel:[0,0] op_sel_hi:[1,0]
    v_pk_mul_f32 v[22:23], v[46:47], v[24:25] op_sel:[0,0] op_sel_hi:[1,0]
    v_pk_fma_f32 v[16:17], v[48:49], v[24:25], v[16:17] op_sel:[0,1,0] op_sel_hi:[1,1,1]
    v_pk_fma_f32 v[18:19], v[50:51], v[24:25], v[18:19] op_sel:[0,1,0] op_sel_hi:[1,1,1]
    v_pk_fma_f32 v[20:21], v[52:53], v[24:25], v[20:21] op_sel:[0,1,0] op_sel_hi:[1,1,1]
    v_pk_fma_f32 v[22:23], v[54:55], v[24:25], v[22:23] op_sel:[0,1,0] op_sel_hi:[1,1,1]
    v_pk_fma_f32 v[16:17], v[56:57], v[26:27], v[16:17] op_sel:[0,0,0] op_sel_hi:[1,0,1]
    v_pk_fma_f32 v[18:19], v[58:59], v[26:27], v[18:19] op_sel:[0,0,0] op_sel_hi:[1,0,1]
    v_pk_fma_f32 v[20:21], v[60:61], v[26:27], v[20:21] op_sel:[0,0,0] op_sel_hi:[1,0,1]
    v_pk_fma_f32 v[22:23], v[62:63], v[26:27], v[22:23] op_sel:[0,0,0] op_sel_hi:[1,0,1]
    v_pk_fma_f32 v[16:17], v[64:65], v[26:27], v[16:17] op_sel:[0,1,0] op_sel_hi:[1,1,1]
    v_pk_fma_f32 v[18:19], v[66:67], v[26:27], v[18:19] op_sel:[0,1,0] op_sel_hi:[1,1,1]
    v_pk_fma_f32 v[20:21], v[68:69], v[26:27], v[20:21] op_sel:[0,1,0] op_sel_hi:[1,1,1]
    v_pk_fma_f32 v[22:23], v[70:71], v[26:27], v[22:23] op_sel:[0,1,0] op_sel_hi:[1,1,1]
    v_pk_fma_f32 v[16:17], v[72:73], v[28:29], v[16:17] op_sel:[0,0,0] op_sel_hi:[1,0,1]
    v_pk_fma_f32 v[18:19], v[74:75], v[28:29], v[18:19] op_sel:[0,0,0] op_sel_hi:[1,0,1]
    v_pk_fma_f32 v[20:21], v[76:77], v[28:29], v[20:21] op_sel:[0,0,0] op_sel_hi:[1,0,1]
    v_pk_fma_f32 v[22:23], v[78:79], v[28:29], v[22:23] op_sel:[0,0,0] op_sel_hi:[1,0,1]
    v_pk_fma_f32 v[16:17], v[80:81], v[28:29], v[16:17] op_sel:[0,1,0] op_sel_hi:[1,1,1]
    v_pk_fma_f32 v[18:19], v[82:83], v[28:29], v[18:19] op_sel:[0,1,0] op_sel_hi:[1,1,1]
    v_pk_fma_f32 v[20:21], v[84:85], v[28:29], v[20:21] op_sel:[0,1,0] op_sel_hi:[1,1,1]
    v_pk_fma_f32 v[22:23], v[86:87], v[28:29], v[22:23] op_sel:[0,1,0] op_sel_hi:[1,1,1]
    v_pk_fma_f32 v[16:17], v[88:89], v[30:31], v[16:17] op_sel:[0,0,0] op_sel_hi:[1,0,1]
    v_pk_fma_f32 v[18:19], v[90:91], v[30:31], v[18:19] op_sel:[0,0,0] op_sel_hi:[1,0,1]
    v_pk_fma_f32 v[20:21], v[92:93], v[30:31], v[20:21] op_sel:[0,0,0] op_sel_hi:[1,0,1]
    v_pk_fma_f32 v[22:23], v[94:95], v[30:31], v[22:23] op_sel:[0,0,0] op_sel_hi:[1,0,1]
    v_pk_fma_f32 v[16:17], v[96:97], v[30:31], v[16:17] op_sel:[0,1,0] op_sel_hi:[1,1,1]
    v_pk_fma_f32 v[18:19], v[98:99], v[30:31], v[18:19] op_sel:[0,1,0] op_sel_hi:[1,1,1]
    v_pk_fma_f32 v[20:21], v[100:101], v[30:31], v[20:21] op_sel:[0,1,0] op_sel_hi:[1,1,1]
    v_pk_fma_f32 v[22:23], v[102:103], v[30:31], v[22:23] op_sel:[0,1,0] op_sel_hi:[1,1,1]
    v_pk_fma_f32 v[16:17], v[104:105], v[32:33], v[16:17] op_sel:[0,0,0] op_sel_hi:[1,0,1]
    v_pk_fma_f32 v[18:19], v[106:107], v[32:33], v[18:19] op_sel:[0,0,0] op_sel_hi:[1,0,1]
    v_pk_fma_f32 v[20:21], v[108:109], v[32:33], v[20:21] op_sel:[0,0,0] op_sel_hi:[1,0,1]
    v_pk_fma_f32 v[22:23], v[110:111], v[32:33], v[22:23] op_sel:[0,0,0] op_sel_hi:[1,0,1]
    v_pk_fma_f32 v[16:17], v[112:113], v[32:33], v[16:17] op_sel:[0,1,0] op_sel_hi:[1,1,1]
    v_pk_fma_f32 v[18:19], v[114:115], v[32:33], v[18:19] op_sel:[0,1,0] op_sel_hi:[1,1,1]
    v_pk_fma_f32 v[20:21], v[116:117], v[32:33], v[20:21] op_sel:[0,1,0] op_sel_hi:[1,1,1]
    v_pk_fma_f32 v[22:23], v[118:119], v[32:33], v[22:23] op_sel:[0,1,0] op_sel_hi:[1,1,1]
    v_pk_fma_f32 v[16:17], v[120:121], v[34:35], v[16:17] op_sel:[0,0,0] op_sel_hi:[1,0,1]
    v_pk_fma_f32 v[18:19], v[122:123], v[34:35], v[18:19] op_sel:[0,0,0] op_sel_hi:[1,0,1]
    v_pk_fma_f32 v[20:21], v[124:125], v[34:35], v[20:21] op_sel:[0,0,0] op_sel_hi:[1,0,1]
    v_pk_fma_f32 v[22:23], v[126:127], v[34:35], v[22:23] op_sel:[0,0,0] op_sel_hi:[1,0,1]
    v_pk_fma_f32 v[16:17], v[128:129], v[34:35], v[16:17] op_sel:[0,1,0] op_sel_hi:[1,1,1]
    v_pk_fma_f32 v[18:19], v[130:131], v[34:35], v[18:19] op_sel:[0,1,0] op_sel_hi:[1,1,1]
    v_pk_fma_f32 v[20:21], v[132:133], v[34:35], v[20:21] op_sel:[0,1,0] op_sel_hi:[1,1,1]
    v_pk_fma_f32 v[22:23], v[134:135], v[34:35], v[22:23] op_sel:[0,1,0] op_sel_hi:[1,1,1]
    v_pk_fma_f32 v[16:17], v[136:137], v[36:37], v[16:17] op_sel:[0,0,0] op_sel_hi:[1,0,1]
    v_pk_fma_f32 v[18:19], v[138:139], v[36:37], v[18:19] op_sel:[0,0,0] op_sel_hi:[1,0,1]
    v_pk_fma_f32 v[20:21], v[140:141], v[36:37], v[20:21] op_sel:[0,0,0] op_sel_hi:[1,0,1]
    v_pk_fma_f32 v[22:23], v[142:143], v[36:37], v[22:23] op_sel:[0,0,0] op_sel_hi:[1,0,1]
    v_pk_fma_f32 v[16:17], v[144:145], v[36:37], v[16:17] op_sel:[0,1,0] op_sel_hi:[1,1,1]
    v_pk_fma_f32 v[18:19], v[146:147], v[36:37], v[18:19] op_sel:[0,1,0] op_sel_hi:[1,1,1]
    v_pk_fma_f32 v[20:21], v[148:149], v[36:37], v[20:21] op_sel:[0,1,0] op_sel_hi:[1,1,1]
    v_pk_fma_f32 v[22:23], v[150:151], v[36:37], v[22:23] op_sel:[0,1,0] op_sel_hi:[1,1,1]
    v_pk_fma_f32 v[16:17], v[152:153], v[38:39], v[16:17] op_sel:[0,0,0] op_sel_hi:[1,0,1]
    v_pk_fma_f32 v[18:19], v[154:155], v[38:39], v[18:19] op_sel:[0,0,0] op_sel_hi:[1,0,1]
    v_pk_fma_f32 v[20:21], v[156:157], v[38:39], v[20:21] op_sel:[0,0,0] op_sel_hi:[1,0,1]
    v_pk_fma_f32 v[22:23], v[158:159], v[38:39], v[22:23] op_sel:[0,0,0] op_sel_hi:[1,0,1]
    v_pk_fma_f32 v[16:17], v[160:161], v[38:39], v[16:17] op_sel:[0,1,0] op_sel_hi:[1,1,1]
    v_pk_fma_f32 v[18:19], v[162:163], v[38:39], v[18:19] op_sel:[0,1,0] op_sel_hi:[1,1,1]
    v_pk_fma_f32 v[20:21], v[164:165], v[38:39], v[20:21] op_sel:[0,1,0] op_sel_hi:[1,1,1]
    v_pk_fma_f32 v[22:23], v[166:167], v[38:39], v[22:23] op_sel:[0,1,0] op_sel_hi:[1,1,1]
    s_nop 1
    v_permlane32_swap_b32 v16, v20
    v_permlane32_swap_b32 v17, v21
    v_permlane32_swap_b32 v18, v22
    v_permlane32_swap_b32 v19, v23
    v_add_f32 v16, v16, v20
    v_add_f32 v17, v17, v21
    v_add_f32 v18, v18, v22
    v_add_f32 v19, v19, v23
    s_nop 0
    v_permlane16_swap_b32 v16, v18
    v_permlane16_swap_b32 v17, v19
    v_add_f32 v16, v16, v18
    v_add_f32 v17, v17, v19
    s_nop 0
    v_add_f32_dpp v16, v16, v16 row_ror:8 row_mask:0xf bank_mask:0xf
    v_add_f32_dpp v17, v17, v17 row_ror:8 row_mask:0xf bank_mask:0xf
    s_nop 0
    v_add_f32_dpp v16, v16, v16 row_ror:4 row_mask:0xf bank_mask:0xf
    v_add_f32_dpp v17, v17, v17 row_ror:4 row_mask:0xf bank_mask:0xf
    s_nop 0
    v_add_f32_dpp v16, v16, v16 row_ror:2 row_mask:0xf bank_mask:0xf
    v_add_f32_dpp v17, v17, v17 row_ror:2 row_mask:0xf bank_mask:0xf
    ds_write_b64 v1, v[16:17] offset:61504
    v_lshlrev_b32 v1, 2, v0
    v_lshlrev_b32 v2, 1, v0
    s_waitcnt lgkmcnt(0)
    s_barrier
    s_cmp_lg_u32 s14, 0
    s_cbranch_scc1 KT_END
    v_add_u32 v1, 61504, v1
    s_mov_b64 exec, 0xffff
    ds_read2_b32 v[16:17], v1 offset0:0 offset1:16
    ds_read2_b32 v[18:19], v1 offset0:32 offset1:48
    s_waitcnt lgkmcnt(0)
    v_pk_add_f32 v[16:17], v[16:17], v[18:19]
    v_add_f32 v16, v16, v17
    v_cvt_pk_bf16_f32 v16, v16, v16
    v_and_b32 v16, 0xffff0000, v16
    v_mul_f32 v16, v16, v8
    v_cvt_pk_bf16_f32 v16, v16, v16
    v_and_b32 v16, 0xffff0000, v16
    v_add_f32 v16, v16, v9
    v_cvt_pk_bf16_f32 v16, v16, v16
    v_and_b32 v16, 0xffff0000, v16
    v_add_f32 v16, v16, v12
    v_cvt_pk_bf16_f32 v16, v16, v16
    buffer_store_short v16, v2, s[40:43], s22 offen
KT_END:
    s_endpgm
K2_REDO:
    s_cmp_lg_u32 s22, 0
    s_cbranch_scc1 K2_STORE
    s_mov_b32 s22, 1
    s_mov_b32 s20, 0
    s_mov_b32 s21, 8
    s_mov_b32 s18, s15
    s_mov_b32 s19, 32
    v_mov_b32 v182, 0xff800000
    v_mov_b32 v183, 0xff800000
K2_MAXL:
    buffer_load_dwordx4 v[56:59], v4, s[8:11], s18 offen
    buffer_load_dwordx4 v[64:67], v5, s[8:11], s18 offen
    buffer_load_dwordx4 v[60:63], v4, s[8:11], s18 offen offset:1024
    s_add_u32 s18, s18, 2560
    s_waitcnt vmcnt(0)
    v_mfma_f32_32x32x16_bf16 v[84:99], v[56:59], v[8:11], 0
    v_mfma_f32_32x32x16_bf16 v[100:115], v[56:59], v[12:15], 0
    v_mfma_f32_32x32x16_bf16 v[116:131], v[60:63], v[8:11], 0
    v_mfma_f32_32x32x16_bf16 v[132:147], v[60:63], v[12:15], 0
    s_nop 9
    v_mfma_f32_32x32x4_2b_bf16 v[84:115], v[64:65], v[16:17], v[84:115] cbsz:1 abid:0
    v_mfma_f32_32x32x4_2b_bf16 v[116:147], v[66:67], v[16:17], v[116:147] cbsz:1 abid:0
    s_nop 15
    s_nop 3
    v_max3_f32 v182, v182, v84, v85
    v_max3_f32 v182, v182, v86, v87
    v_max3_f32 v182, v182, v88, v89
    v_max3_f32 v182, v182, v90, v91
    v_max3_f32 v182, v182, v92, v93
    v_max3_f32 v182, v182, v94, v95
    v_max3_f32 v182, v182, v96, v97
    v_max3_f32 v182, v182, v98, v99
    v_max3_f32 v183, v183, v100, v101
    v_max3_f32 v183, v183, v102, v103
    v_max3_f32 v183, v183, v104, v105
    v_max3_f32 v183, v183, v106, v107
    v_max3_f32 v183, v183, v108, v109
    v_max3_f32 v183, v183, v110, v111
    v_max3_f32 v183, v183, v112, v113
    v_max3_f32 v183, v183, v114, v115
    v_max3_f32 v182, v182, v116, v117
    v_max3_f32 v182, v182, v118, v119
    v_max3_f32 v182, v182, v120, v121
    v_max3_f32 v182, v182, v122, v123
    v_max3_f32 v182, v182, v124, v125
    v_max3_f32 v182, v182, v126, v127
    v_max3_f32 v182, v182, v128, v129
    v_max3_f32 v182, v182, v130, v131
    v_max3_f32 v183, v183, v132, v133
    v_max3_f32 v183, v183, v134, v135
    v_max3_f32 v183, v183, v136, v137
    v_max3_f32 v183, v183, v138, v139
    v_max3_f32 v183, v183, v140, v141
    v_max3_f32 v183, v183, v142, v143
    v_max3_f32 v183, v183, v144, v145
    v_max3_f32 v183, v183, v146, v147
    s_sub_u32 s19, s19, 1
    s_cmp_lg_u32 s19, 0
    s_cbranch_scc1 K2_MAXL
    v_mov_b32 v40, 0
    v_mov_b32 v41, 0
    v_mov_b32 v42, 0
    v_mov_b32 v43, 0
    v_mov_b32 v44, 0
    v_mov_b32 v45, 0
    v_mov_b32 v46, 0
    v_mov_b32 v47, 0
    v_mov_b32 v48, 0
    v_mov_b32 v49, 0
    v_mov_b32 v50, 0
    v_mov_b32 v51, 0
    v_mov_b32 v52, 0
    v_mov_b32 v53, 0
    v_mov_b32 v54, 0
    v_mov_b32 v55, 0
    s_mov_b32 exec_lo, 0x100000
    s_mov_b32 exec_hi, 0x100000
    v_mov_b32 v40, 0x3f803f80
    v_mov_b32 v41, 0x3f803f80
    v_mov_b32 v42, 0x3f803f80
    v_mov_b32 v43, 0x3f803f80
    v_mov_b32 v44, 0x3f803f80
    v_mov_b32 v45, 0x3f803f80
    v_mov_b32 v46, 0x3f803f80
    v_mov_b32 v47, 0x3f803f80
    v_mov_b32 v48, 0x3f803f80
    v_mov_b32 v49, 0x3f803f80
    v_mov_b32 v50, 0x3f803f80
    v_mov_b32 v51, 0x3f803f80
    v_mov_b32 v52, 0x3f803f80
    v_mov_b32 v53, 0x3f803f80
    v_mov_b32 v54, 0x3f803f80
    v_mov_b32 v55, 0x3f803f80
    s_mov_b64 exec, -1
    buffer_load_dwordx4 v[28:31], v4, s[8:11], s15 offen
    buffer_load_dwordx4 v[36:39], v5, s[8:11], s15 offen
    buffer_load_dwordx4 v[32:35], v4, s[8:11], s15 offen offset:1024
    s_mov_b32 exec_lo, 0xfffff
    s_mov_b32 exec_hi, 0xfffff
    s_mov_b32 s46, 5242880
    buffer_load_dwordx4 v[40:43], v7, s[8:11], s46 offen
    s_mov_b32 s46, 5263360
    buffer_load_dwordx4 v[44:47], v7, s[8:11], s46 offen
    s_mov_b32 s46, 5283840
    buffer_load_dwordx4 v[48:51], v7, s[8:11], s46 offen
    s_mov_b32 s46, 5304320
    buffer_load_dwordx4 v[52:55], v7, s[8:11], s46 offen
    s_mov_b64 exec, -1
    v_mov_b32 v116, 0
    v_mov_b32 v117, 0
    v_mov_b32 v118, 0
    v_mov_b32 v119, 0
    v_mov_b32 v120, 0
    v_mov_b32 v121, 0
    v_mov_b32 v122, 0
    v_mov_b32 v123, 0
    v_mov_b32 v124, 0
    v_mov_b32 v125, 0
    v_mov_b32 v126, 0
    v_mov_b32 v127, 0
    v_mov_b32 v128, 0
    v_mov_b32 v129, 0
    v_mov_b32 v130, 0
    v_mov_b32 v131, 0
    v_mov_b32 v132, 0
    v_mov_b32 v133, 0
    v_mov_b32 v134, 0
    v_mov_b32 v135, 0
    v_mov_b32 v136, 0
    v_mov_b32 v137, 0
    v_mov_b32 v138, 0
    v_mov_b32 v139, 0
    v_mov_b32 v140, 0
    v_mov_b32 v141, 0
    v_mov_b32 v142, 0
    v_mov_b32 v143, 0
    v_mov_b32 v144, 0
    v_mov_b32 v145, 0
    v_mov_b32 v146, 0
    v_mov_b32 v147, 0
    v_mov_b32 v24, 0
    v_mov_b32 v25, 0
    v_mov_b32 v26, 0
    v_mov_b32 v27, 0
    v_mov_b32 v80, 0
    v_mov_b32 v81, 0
    v_mov_b32 v82, 0
    v_mov_b32 v83, 0
    s_branch K2_RAW
K2_END:
    s_endpgm
.section .rodata,"a"
.p2align 6
.amdhsa_kernel sequential_preLN__mha_block__moe_arch_mod__prompt_kernel
  .amdhsa_next_free_vgpr 256
  .amdhsa_next_free_sgpr 102
  .amdhsa_accum_offset 256
  .amdhsa_group_segment_fixed_size 0
  .amdhsa_kernarg_size 88
  .amdhsa_user_sgpr_count 2
  .amdhsa_user_sgpr_kernarg_segment_ptr 1
  .amdhsa_system_sgpr_workgroup_id_x 1
.end_amdhsa_kernel
```
